```python
import torch

def _softmax(x, axis=-1):
    return torch.softmax(x, dim=axis)
def _gelu(x):
    return torch.nn.functional.gelu(x, approximate="tanh")
def _silu(x):
    return torch.nn.functional.silu(x)
def _sigmoid(x):
    return torch.sigmoid(x)
def _layernorm(x, axis=-1, eps=1e-5):
    m = x.mean(dim=axis, keepdim=True)
    v = x.var(dim=axis, keepdim=True, unbiased=False)
    return (x - m) / torch.sqrt(v + eps)
def _scatter_add(tgt, idx, src, axis=0):
    return tgt.clone().index_add_(axis, idx, src)
def _segment_sum(src, seg, n):
    out = torch.zeros((n,) + src.shape[1:], dtype=src.dtype)
    return out.index_add_(0, seg, src)
def _pad(x, pw):
    flat = tuple(v for pair in reversed(pw) for v in pair)
    return torch.nn.functional.pad(x, flat)

kernel_name = 'standalone__self_sup_conv_stem_hubert__speech'

def setup_inputs():

    _w = (lambda a: (lambda t: t.to(torch.bfloat16) if t.is_floating_point() else t)(torch.as_tensor(a)))
    B, T, D, K = 2, 1000, 512, 15
    scale = (1.0 / (K * D)) ** 0.5
    return {
        "x": _w((lambda *s: torch.randn(*s, dtype=torch.bfloat16) * 0.05)(B, T, D)),
        "w": _w((lambda *s: torch.randn(*s, dtype=torch.bfloat16) * 0.05)(K, D, D) * scale),
        "b": _w((lambda *s: torch.randn(*s, dtype=torch.bfloat16) * 0.05)(D) * 0.1),
        "gamma": _w(torch.ones((D,), dtype=float)),
        "beta": _w(torch.zeros((D,), dtype=float)),
    }

def reference(x, w, b, gamma, beta):
    B, T, D = x.shape
    K = w.shape[0]
    s = 2
    L = (T - K) // s + 1
    y = torch.einsum('blc,cd->bld', x[:, 0 : s * L : s, :], w[0])
    for i in range(1, K):
        y = y + torch.einsum('blc,cd->bld', x[:, i : i + s * L : s, :], w[i])
    y = y + b[None, None, :]
    mu = y.mean(1, keepdims=True)
    var = ((y - mu) ** 2).mean(1, keepdims=True)
    yn = (y - mu) / torch.sqrt(var + 1e-5)
    yn = yn * gamma[None, None, :] + beta[None, None, :]
    return _gelu(yn)
```

```asm
; @launch grid=(256,1,1) block=(512,1,1) lds=162432
.amdgcn_target "amdgcn-amd-amdhsa--gfx950"
.text
.globl standalone__self_sup_conv_stem_hubert__speech_kernel
.p2align 8
.type standalone__self_sup_conv_stem_hubert__speech_kernel,@function
standalone__self_sup_conv_stem_hubert__speech_kernel:
    s_cmp_ge_u32 s2, 256
    s_cbranch_scc1 L_end
    s_load_dwordx16 s[4:19], s[0:1], 0
    v_lshrrev_b32 v9, 6, v0
    v_and_b32 v1, 63, v0
    s_and_b32 s46, s2, 7
    v_readfirstlane_b32 s36, v9
    s_lshr_b32 s47, s2, 3
    s_lshr_b32 s43, s46, 2
    s_and_b32 s46, s46, 3
    s_lshl_b32 s46, s46, 1
    s_and_b32 s41, s47, 1
    s_add_u32 s41, s41, s46
    s_lshr_b32 s40, s47, 1
    s_and_b32 s40, s40, 3
    s_lshr_b32 s42, s47, 3
    s_and_b32 s61, s36, 3
    s_mul_i32 s55, s43, 1024000
    s_lshl_b32 s47, s42, 18
    s_add_u32 s55, s55, s47
    s_lshl_b32 s47, s40, 8
    s_add_u32 s55, s55, s47
    s_lshl_b32 s54, s40, 17
    s_lshl_b32 s47, s41, 7
    s_add_u32 s54, s54, s47
    s_mov_b32 s22, 2048000
    s_mov_b32 s23, 0x20000
    s_mov_b32 s26, 7864320
    s_mov_b32 s27, 0x20000
    s_cmp_lt_u32 s36, 4
    s_cbranch_scc1 L_compute
    v_lshrrev_b32 v9, 3, v1
    v_and_b32 v10, 7, v1
    v_lshlrev_b32 v11, 11, v9
    v_lshlrev_b32 v12, 4, v10
    v_add3_u32 v2, v11, v12, s55
    s_and_b32 s46, s61, 1
    s_lshl_b32 s46, s46, 1
    v_bfe_u32 v11, v1, 4, 1
    v_or_b32 v11, s46, v11
    v_lshrrev_b32 v12, 1, v10
    v_xor_b32 v11, v11, v12
    v_lshlrev_b32 v11, 5, v11
    v_and_b32 v12, 1, v10
    v_lshl_add_u32 v11, v12, 4, v11
    v_lshlrev_b32 v9, 10, v9
    s_lshl_b32 s46, s61, 13
    s_add_u32 s46, s46, s54
    v_add3_u32 v3, v9, v11, s46
    s_lshl_b32 s37, s61, 10
    s_add_u32 s37, s37, 71808
    s_mul_i32 s38, s61, 1056
    s_lshl_b32 s54, s61, 14
    s_and_b32 s68, s42, 1
    s_lshl_b32 s68, s68, 15
    s_sub_u32 s69, 0, s68
    s_waitcnt lgkmcnt(0)
    s_mov_b32 s20, s4
    s_mov_b32 s21, s5
    s_mov_b32 s24, s6
    s_mov_b32 s25, s7
    s_add_u32 m0, s38, 0
    s_add_u32 s39, s54, 0
    buffer_load_dwordx4 v2, s[20:23], s39 offen  lds
    s_add_u32 m0, s38, 4224
    s_add_u32 s39, s54, 65536
    buffer_load_dwordx4 v2, s[20:23], s39 offen  lds
    s_add_u32 m0, s38, 8448
    s_add_u32 s39, s54, 131072
    buffer_load_dwordx4 v2, s[20:23], s39 offen  lds
    s_add_u32 m0, s38, 12672
    s_add_u32 s39, s54, 196608
    buffer_load_dwordx4 v2, s[20:23], s39 offen  lds
    s_cmp_lg_u32 s61, 0
    s_cbranch_scc1 L_x17_1
    s_mov_b32 m0, 16896
    s_mov_b32 s39, 262144
    buffer_load_dwordx4 v2, s[20:23], s39 offen  lds
L_x17_1:
    s_add_u32 m0, s37, 0
    s_mov_b32 s39, 0
    buffer_load_dwordx4 v3, s[24:27], s39 offen  lds
    s_add_u32 m0, s37, 4096
    s_mov_b32 s39, 1048576
    buffer_load_dwordx4 v3, s[24:27], s39 offen  lds
    s_add_u32 m0, s37, 8192
    s_mov_b32 s39, 2097152
    buffer_load_dwordx4 v3, s[24:27], s39 offen  lds
    s_add_u32 m0, s37, 12288
    s_mov_b32 s39, 3145728
    buffer_load_dwordx4 v3, s[24:27], s39 offen  lds
    s_add_u32 m0, s37, 16384
    s_mov_b32 s39, 4194304
    buffer_load_dwordx4 v3, s[24:27], s39 offen  lds
    s_add_u32 m0, s37, 20480
    s_mov_b32 s39, 5242880
    buffer_load_dwordx4 v3, s[24:27], s39 offen  lds
    s_lshl_b32 s58, s43, 3
    s_add_u32 s58, s58, s41
    s_lshl_b32 s59, s42, 2
    s_add_u32 s59, s59, s40
    s_lshl_b32 s47, s58, 7
    s_add_u32 s47, s47, 4194304
    s_add_u32 s48, s18, s47
    s_addc_u32 s49, s19, 0
    s_load_dword s44, s[48:49], 0
    s_lshl_b32 s60, s41, 4
    s_add_u32 s60, s60, s59
    s_lshl_b32 s60, s60, 3
    s_add_u32 s8, s8, s60
    s_addc_u32 s9, s9, 0
    s_load_dwordx2 s[50:51], s[8:9], 0
    s_add_u32 s10, s10, s60
    s_addc_u32 s11, s11, 0
    s_load_dwordx2 s[52:53], s[10:11], 0
    s_add_u32 s12, s12, s60
    s_addc_u32 s13, s13, 0
    s_load_dwordx2 s[56:57], s[12:13], 0
    s_mov_b32 s28, s18
    s_mov_b32 s29, s19
    s_mov_b32 s30, 4231168
    s_mov_b32 s31, 0x20000
    s_mov_b32 s32, s14
    s_mov_b32 s33, s15
    s_mov_b32 s34, 1009664
    s_mov_b32 s35, 0x20000
    s_lshl_b32 s46, s58, 4
    s_add_u32 s46, s46, s59
    s_lshl_b32 s47, s46, 7
    s_lshl_b32 s48, s61, 4
    s_add_u32 s47, s47, s48
    s_add_u32 s47, s47, 4198400
    v_mov_b32 v136, s47
    s_lshl_b32 s46, s46, 14
    s_lshl_b32 s47, s61, 12
    s_add_u32 s46, s46, s47
    v_lshl_add_u32 v135, v1, 7, s46
    v_cmp_gt_u32 vcc, 32, v1
    v_mov_b32 v9, 0x7ffffff0
    s_lshr_b32 s47, s36, 2
    v_cndmask_b32 v135, v9, v135, vcc
    s_lshl_b32 s47, s47, 9
    s_add_u32 s46, s46, s47
    v_lshrrev_b32 v9, 5, v1
    v_lshlrev_b32 v10, 10, v9
    v_and_b32 v11, 31, v1
    v_lshl_add_u32 v10, v11, 4, v10
    v_add_u32 v8, s46, v10
    v_and_b32 v10, 15, v1
    v_lshl_add_u32 v9, v10, 3, v9
    v_bfe_u32 v10, v1, 4, 1
    v_lshl_add_u32 v9, v10, 1, v9
    s_lshl_b32 s46, s61, 7
    s_lshr_b32 s47, s36, 2
    s_lshl_b32 s47, s47, 2
    s_add_u32 s46, s46, s47
    v_add_u32 v11, s46, v9
    v_lshrrev_b32 v10, 4, v1
    s_movk_i32 s47, 493
    v_cmp_gt_u32 s[62:63], s47, v11
    s_mul_i32 s46, s43, 504832
    s_add_u32 s46, s46, s60
    v_lshl_add_u32 v129, v11, 10, s46
    v_and_b32 v9, 1, v10
    v_lshlrev_b32 v9, 1, v9
    v_lshrrev_b32 v10, 1, v10
    v_or_b32 v9, v9, v10
    s_lshl_b32 s46, s36, 6
    s_add_u32 s46, s46, 161920
    v_lshl_add_u32 v130, v9, 2, s46
    v_bfe_u32 v9, v1, 2, 3
    v_and_b32 v10, 3, v1
    v_lshlrev_b32 v10, 2, v10
    v_lshl_add_u32 v10, v9, 6, v10
    v_add_u32 v131, 161920, v10
    v_and_b32 v10, 3, v1
    v_lshlrev_b32 v10, 2, v10
    v_add_u32 v128, 161952, v10
    v_mov_b32 v127, 0x42800000
    v_cmp_eq_u32 vcc, 3, v9
    v_mov_b32 v10, 0x42600000
    s_nop 0
    v_cndmask_b32 v127, v127, v10, vcc
    v_cmp_eq_u32 vcc, 7, v9
    v_mov_b32 v10, 0x42540000
    s_nop 0
    v_cndmask_b32 v127, v127, v10, vcc
    s_add_u32 m0, s37, 24576
    s_mov_b32 s39, 6291456
    buffer_load_dwordx4 v3, s[24:27], s39 offen  lds
    s_add_u32 m0, s37, 28672
    s_mov_b32 s39, 7340032
    buffer_load_dwordx4 v3, s[24:27], s39 offen  lds
    s_add_u32 m0, s37, 32768
    s_mov_b32 s39, 32768
    buffer_load_dwordx4 v3, s[24:27], s39 offen  lds
    s_add_u32 m0, s37, 36864
    s_mov_b32 s39, 1081344
    buffer_load_dwordx4 v3, s[24:27], s39 offen  lds
    s_waitcnt vmcnt(6)
    s_barrier
    s_add_u32 m0, s37, 40960
    s_mov_b32 s39, 2129920
    buffer_load_dwordx4 v3, s[24:27], s39 offen  lds
    s_add_u32 m0, s37, 45056
    s_mov_b32 s39, 3178496
    buffer_load_dwordx4 v3, s[24:27], s39 offen  lds
    s_add_u32 m0, s37, 49152
    s_mov_b32 s39, 4227072
    buffer_load_dwordx4 v3, s[24:27], s39 offen  lds
    s_add_u32 m0, s37, 53248
    s_mov_b32 s39, 5275648
    buffer_load_dwordx4 v3, s[24:27], s39 offen  lds
    s_add_u32 m0, s38, 17952
    s_add_u32 s39, s54, 128
    buffer_load_dwordx4 v2, s[20:23], s39 offen  lds
    s_add_u32 m0, s38, 22176
    s_add_u32 s39, s54, 65664
    buffer_load_dwordx4 v2, s[20:23], s39 offen  lds
    s_add_u32 m0, s38, 26400
    s_add_u32 s39, s54, 131200
    buffer_load_dwordx4 v2, s[20:23], s39 offen  lds
    s_add_u32 m0, s38, 30624
    s_add_u32 s39, s54, 196736
    buffer_load_dwordx4 v2, s[20:23], s39 offen  lds
    s_waitcnt vmcnt(12)
    s_barrier
    s_add_u32 m0, s37, 57344
    s_mov_b32 s39, 6324224
    buffer_load_dwordx4 v3, s[24:27], s39 offen  lds
    s_add_u32 m0, s37, 61440
    s_mov_b32 s39, 7372800
    buffer_load_dwordx4 v3, s[24:27], s39 offen  lds
    s_cmp_lg_u32 s61, 0
    s_cbranch_scc1 L_x17_2
    s_mov_b32 m0, 34848
    s_mov_b32 s39, 262272
    buffer_load_dwordx4 v2, s[20:23], s39 offen  lds
L_x17_2:
    s_waitcnt vmcnt(12)
    s_barrier
    s_add_u32 m0, s37, 65536
    s_mov_b32 s39, 65536
    buffer_load_dwordx4 v3, s[24:27], s39 offen  lds
    s_add_u32 m0, s37, 69632
    s_mov_b32 s39, 1114112
    buffer_load_dwordx4 v3, s[24:27], s39 offen  lds
    s_waitcnt vmcnt(12)
    s_barrier
    s_add_u32 m0, s37, 73728
    s_mov_b32 s39, 2162688
    buffer_load_dwordx4 v3, s[24:27], s39 offen  lds
    s_add_u32 m0, s37, 77824
    s_mov_b32 s39, 3211264
    buffer_load_dwordx4 v3, s[24:27], s39 offen  lds
    s_waitcnt vmcnt(10)
    s_barrier
    s_add_u32 m0, s37, 81920
    s_mov_b32 s39, 4259840
    buffer_load_dwordx4 v3, s[24:27], s39 offen  lds
    s_add_u32 m0, s37, 86016
    s_mov_b32 s39, 5308416
    buffer_load_dwordx4 v3, s[24:27], s39 offen  lds
    s_add_u32 m0, s37, 0
    s_mov_b32 s39, 6356992
    buffer_load_dwordx4 v3, s[24:27], s39 offen  lds
    s_add_u32 m0, s37, 4096
    s_mov_b32 s39, 7405568
    buffer_load_dwordx4 v3, s[24:27], s39 offen  lds
    s_add_u32 m0, s38, 35904
    s_add_u32 s39, s54, 1024
    buffer_load_dwordx4 v2, s[20:23], s39 offen  lds
    s_add_u32 m0, s38, 40128
    s_add_u32 s39, s54, 66560
    buffer_load_dwordx4 v2, s[20:23], s39 offen  lds
    s_add_u32 m0, s38, 44352
    s_add_u32 s39, s54, 132096
    buffer_load_dwordx4 v2, s[20:23], s39 offen  lds
    s_add_u32 m0, s38, 48576
    s_add_u32 s39, s54, 197632
    buffer_load_dwordx4 v2, s[20:23], s39 offen  lds
    s_waitcnt vmcnt(10)
    s_barrier
    s_add_u32 m0, s37, 8192
    s_mov_b32 s39, 98304
    buffer_load_dwordx4 v3, s[24:27], s39 offen  lds
    s_add_u32 m0, s37, 12288
    s_mov_b32 s39, 1146880
    buffer_load_dwordx4 v3, s[24:27], s39 offen  lds
    s_add_u32 m0, s37, 16384
    s_mov_b32 s39, 2195456
    buffer_load_dwordx4 v3, s[24:27], s39 offen  lds
    s_add_u32 m0, s37, 20480
    s_mov_b32 s39, 3244032
    buffer_load_dwordx4 v3, s[24:27], s39 offen  lds
    s_cmp_lg_u32 s61, 0
    s_cbranch_scc1 L_x17_3
    s_mov_b32 m0, 52800
    s_mov_b32 s39, 263168
    buffer_load_dwordx4 v2, s[20:23], s39 offen  lds
L_x17_3:
    s_add_u32 m0, s37, 24576
    s_mov_b32 s39, 4292608
    buffer_load_dwordx4 v3, s[24:27], s39 offen  lds
    s_add_u32 m0, s37, 28672
    s_mov_b32 s39, 5341184
    buffer_load_dwordx4 v3, s[24:27], s39 offen  lds
    s_add_u32 m0, s37, 32768
    s_mov_b32 s39, 6389760
    buffer_load_dwordx4 v3, s[24:27], s39 offen  lds
    s_waitcnt vmcnt(13)
    s_barrier
    s_add_u32 m0, s37, 36864
    s_mov_b32 s39, 7438336
    buffer_load_dwordx4 v3, s[24:27], s39 offen  lds
    s_add_u32 m0, s37, 40960
    s_mov_b32 s39, 524288
    buffer_load_dwordx4 v3, s[24:27], s39 offen  lds
    s_add_u32 m0, s37, 45056
    s_mov_b32 s39, 1572864
    buffer_load_dwordx4 v3, s[24:27], s39 offen  lds
    s_add_u32 m0, s37, 49152
    s_mov_b32 s39, 2621440
    buffer_load_dwordx4 v3, s[24:27], s39 offen  lds
    s_add_u32 m0, s37, 53248
    s_mov_b32 s39, 3670016
    buffer_load_dwordx4 v3, s[24:27], s39 offen  lds
    s_add_u32 m0, s37, 57344
    s_mov_b32 s39, 4718592
    buffer_load_dwordx4 v3, s[24:27], s39 offen  lds
    s_add_u32 m0, s37, 61440
    s_mov_b32 s39, 5767168
    buffer_load_dwordx4 v3, s[24:27], s39 offen  lds
    s_waitcnt vmcnt(12)
    s_barrier
    s_add_u32 m0, s38, 53856
    s_add_u32 s39, s54, 1152
    buffer_load_dwordx4 v2, s[20:23], s39 offen  lds
    s_add_u32 m0, s38, 58080
    s_add_u32 s39, s54, 66688
    buffer_load_dwordx4 v2, s[20:23], s39 offen  lds
    s_add_u32 m0, s38, 62304
    s_add_u32 s39, s54, 132224
    buffer_load_dwordx4 v2, s[20:23], s39 offen  lds
    s_add_u32 m0, s38, 66528
    s_add_u32 s39, s54, 197760
    buffer_load_dwordx4 v2, s[20:23], s39 offen  lds
    s_cmp_lg_u32 s61, 0
    s_cbranch_scc1 L_x17_4
    s_mov_b32 m0, 70752
    s_mov_b32 s39, 263296
    buffer_load_dwordx4 v2, s[20:23], s39 offen  lds
L_x17_4:
    s_add_u32 m0, s37, 65536
    s_mov_b32 s39, 6815744
    buffer_load_dwordx4 v3, s[24:27], s39 offen  lds
    s_add_u32 m0, s37, 69632
    s_mov_b32 s39, 557056
    buffer_load_dwordx4 v3, s[24:27], s39 offen  lds
    s_add_u32 m0, s37, 73728
    s_mov_b32 s39, 1605632
    buffer_load_dwordx4 v3, s[24:27], s39 offen  lds
    s_waitcnt vmcnt(15)
    s_barrier
    s_add_u32 m0, s37, 77824
    s_mov_b32 s39, 2654208
    buffer_load_dwordx4 v3, s[24:27], s39 offen  lds
    s_add_u32 m0, s37, 81920
    s_mov_b32 s39, 3702784
    buffer_load_dwordx4 v3, s[24:27], s39 offen  lds
    s_add_u32 m0, s37, 86016
    s_mov_b32 s39, 4751360
    buffer_load_dwordx4 v3, s[24:27], s39 offen  lds
    s_add_u32 m0, s37, 0
    s_mov_b32 s39, 5799936
    buffer_load_dwordx4 v3, s[24:27], s39 offen  lds
    s_add_u32 m0, s37, 4096
    s_mov_b32 s39, 6848512
    buffer_load_dwordx4 v3, s[24:27], s39 offen  lds
    s_waitcnt vmcnt(16)
    s_barrier
    s_add_u32 m0, s37, 8192
    s_mov_b32 s39, 589824
    buffer_load_dwordx4 v3, s[24:27], s39 offen  lds
    s_add_u32 m0, s37, 12288
    s_mov_b32 s39, 1638400
    buffer_load_dwordx4 v3, s[24:27], s39 offen  lds
    s_add_u32 m0, s37, 16384
    s_mov_b32 s39, 2686976
    buffer_load_dwordx4 v3, s[24:27], s39 offen  lds
    s_add_u32 m0, s37, 20480
    s_mov_b32 s39, 3735552
    buffer_load_dwordx4 v3, s[24:27], s39 offen  lds
    s_waitcnt vmcnt(16)
    s_barrier
    s_add_u32 m0, s37, 24576
    s_mov_b32 s39, 4784128
    buffer_load_dwordx4 v3, s[24:27], s39 offen  lds
    s_add_u32 m0, s37, 28672
    s_mov_b32 s39, 5832704
    buffer_load_dwordx4 v3, s[24:27], s39 offen  lds
    s_add_u32 m0, s37, 32768
    s_mov_b32 s39, 6881280
    buffer_load_dwordx4 v3, s[24:27], s39 offen  lds
    s_add_u32 m0, s37, 36864
    s_mov_b32 s39, 622592
    buffer_load_dwordx4 v3, s[24:27], s39 offen  lds
    s_waitcnt vmcnt(12)
    s_barrier
    s_add_u32 m0, s37, 40960
    s_mov_b32 s39, 1671168
    buffer_load_dwordx4 v3, s[24:27], s39 offen  lds
    s_add_u32 m0, s37, 45056
    s_mov_b32 s39, 2719744
    buffer_load_dwordx4 v3, s[24:27], s39 offen  lds
    s_add_u32 m0, s37, 49152
    s_mov_b32 s39, 3768320
    buffer_load_dwordx4 v3, s[24:27], s39 offen  lds
    s_add_u32 m0, s37, 53248
    s_mov_b32 s39, 4816896
    buffer_load_dwordx4 v3, s[24:27], s39 offen  lds
    s_waitcnt vmcnt(12)
    s_barrier
    s_add_u32 m0, s37, 57344
    s_mov_b32 s39, 5865472
    buffer_load_dwordx4 v3, s[24:27], s39 offen  lds
    s_add_u32 m0, s37, 61440
    s_mov_b32 s39, 6914048
    buffer_load_dwordx4 v3, s[24:27], s39 offen  lds
    buffer_load_dword v133, v135, s[28:31], 0 offen sc1
    s_waitcnt vmcnt(11)
    s_barrier
    s_waitcnt vmcnt(7)
    s_barrier
    s_waitcnt vmcnt(3)
    s_barrier
    s_waitcnt vmcnt(1)
    s_barrier
    s_waitcnt lgkmcnt(0)
    s_add_u32 s45, s44, 1
    v_mov_b32 v124, s45
    s_lshl_b32 s90, s50, 16
    s_and_b32 s91, s50, 0xffff0000
    s_lshl_b32 s92, s51, 16
    s_and_b32 s93, s51, 0xffff0000
    v_and_b32 v10, 2, v1
    v_cmp_eq_u32 vcc, 0, v10
    v_mov_b32 v10, s53
    v_mov_b32 v11, s52
    v_cndmask_b32 v125, v10, v11, vcc
    v_mov_b32 v10, s57
    v_mov_b32 v11, s56
    v_cndmask_b32 v126, v10, v11, vcc
    v_and_b32 v10, 1, v1
    v_cmp_eq_u32 vcc, 0, v10
    v_lshlrev_b32 v10, 16, v125
    v_and_b32 v11, 0xffff0000, v125
    v_cndmask_b32 v125, v11, v10, vcc
    v_lshlrev_b32 v10, 16, v126
    v_and_b32 v11, 0xffff0000, v126
    v_cndmask_b32 v126, v11, v10, vcc
    s_mov_b32 s100, 200000
    s_mov_b32 s3, 0x3b04eedd
    s_mov_b32 s98, 0xbdd2d3e8
    s_mov_b32 s99, s98
    v_mov_b32 v138, 0xc0135761
    v_mov_b32 v139, v138
    v_mov_b32 v140, 0x3727c5ac
    s_branch L_epi
L_compute:
    v_and_b32 v9, 7, v1
    v_lshlrev_b32 v9, 20, v9
    v_lshrrev_b32 v10, 3, v1
    s_lshl_b32 s46, s42, 3
    v_add_u32 v10, s46, v10
    v_lshlrev_b32 v10, 10, v10
    v_add3_u32 v5, v9, v10, s54
    s_waitcnt lgkmcnt(0)
    s_mov_b32 s20, s4
    s_mov_b32 s21, s5
    s_mov_b32 s24, s6
    s_mov_b32 s25, s7
    s_mov_b32 s64, s16
    s_mov_b32 s65, s17
    s_mov_b32 s66, 256
    s_mov_b32 s67, 0x20000
    s_mov_b32 s101, 99
    s_mov_b32 s3, 0
    s_lshr_b32 s46, s6, 7
    s_sub_u32 s48, 3, s46
    s_and_b32 s48, s48, 7
    s_lshr_b32 s49, s48, 1
    s_lshr_b32 s50, s41, 1
    s_cmp_eq_u32 s49, s50
    s_cselect_b32 s101, s61, s101
    s_xor_b32 s48, s48, s41
    s_and_b32 s48, s48, 1
    s_cselect_b32 s3, 1, s3
    s_sub_u32 s48, 7, s46
    s_and_b32 s48, s48, 7
    s_lshr_b32 s49, s48, 1
    s_lshr_b32 s50, s41, 1
    s_cmp_eq_u32 s49, s50
    s_cselect_b32 s101, s61, s101
    s_xor_b32 s48, s48, s41
    s_and_b32 s48, s48, 1
    s_cselect_b32 s3, 1, s3
    s_lshl_b32 s48, s3, 7
    v_xor_b32 v5, s48, v5
    v_cmp_le_u32 vcc, 24, v1
    s_not_b64 s[48:49], vcc
    s_cmp_eq_u32 s3, 1
    s_cselect_b64 vcc, vcc, s[48:49]
    v_mov_b32 v9, 0x7ffffff0
    s_nop 0
    v_cndmask_b32 v5, v9, v5, vcc
    s_lshl_b32 s58, s43, 3
    s_add_u32 s58, s58, s41
    s_lshl_b32 s59, s42, 2
    s_add_u32 s59, s59, s40
    s_lshl_b32 s47, s58, 7
    s_add_u32 s47, s47, 4194304
    s_add_u32 s48, s18, s47
    s_addc_u32 s49, s19, 0
    s_load_dword s44, s[48:49], 0
    s_lshl_b32 s60, s41, 4
    s_add_u32 s60, s60, s59
    s_lshl_b32 s60, s60, 3
    s_add_u32 s8, s8, s60
    s_addc_u32 s9, s9, 0
    s_load_dwordx2 s[50:51], s[8:9], 0
    s_add_u32 s10, s10, s60
    s_addc_u32 s11, s11, 0
    s_load_dwordx2 s[52:53], s[10:11], 0
    s_add_u32 s12, s12, s60
    s_addc_u32 s13, s13, 0
    s_load_dwordx2 s[56:57], s[12:13], 0
    s_mov_b32 s28, s18
    s_mov_b32 s29, s19
    s_mov_b32 s30, 4231168
    s_mov_b32 s31, 0x20000
    s_mov_b32 s32, s14
    s_mov_b32 s33, s15
    s_mov_b32 s34, 1009664
    s_mov_b32 s35, 0x20000
    s_lshl_b32 s46, s58, 4
    s_add_u32 s46, s46, s59
    s_lshl_b32 s47, s46, 7
    s_lshl_b32 s48, s61, 4
    s_add_u32 s47, s47, s48
    s_add_u32 s47, s47, 4198400
    v_mov_b32 v136, s47
    s_lshl_b32 s46, s46, 14
    s_lshl_b32 s47, s61, 12
    s_add_u32 s46, s46, s47
    v_lshl_add_u32 v135, v1, 7, s46
    v_cmp_gt_u32 vcc, 32, v1
    v_mov_b32 v9, 0x7ffffff0
    s_lshr_b32 s47, s36, 2
    v_cndmask_b32 v135, v9, v135, vcc
    s_lshl_b32 s47, s47, 9
    s_add_u32 s46, s46, s47
    v_lshrrev_b32 v9, 5, v1
    v_lshlrev_b32 v10, 10, v9
    v_and_b32 v11, 31, v1
    v_lshl_add_u32 v10, v11, 4, v10
    v_add_u32 v8, s46, v10
    v_and_b32 v10, 15, v1
    v_lshl_add_u32 v9, v10, 3, v9
    v_bfe_u32 v10, v1, 4, 1
    v_lshl_add_u32 v9, v10, 1, v9
    s_lshl_b32 s46, s61, 7
    s_lshr_b32 s47, s36, 2
    s_lshl_b32 s47, s47, 2
    s_add_u32 s46, s46, s47
    v_add_u32 v11, s46, v9
    v_lshrrev_b32 v10, 4, v1
    s_movk_i32 s47, 493
    v_cmp_gt_u32 s[62:63], s47, v11
    s_mul_i32 s46, s43, 504832
    s_add_u32 s46, s46, s60
    v_lshl_add_u32 v129, v11, 10, s46
    v_and_b32 v9, 1, v10
    v_lshlrev_b32 v9, 1, v9
    v_lshrrev_b32 v10, 1, v10
    v_or_b32 v9, v9, v10
    s_lshl_b32 s46, s36, 6
    s_add_u32 s46, s46, 161920
    v_lshl_add_u32 v130, v9, 2, s46
    v_bfe_u32 v9, v1, 2, 3
    v_and_b32 v10, 3, v1
    v_lshlrev_b32 v10, 2, v10
    v_lshl_add_u32 v10, v9, 6, v10
    v_add_u32 v131, 161920, v10
    v_and_b32 v10, 3, v1
    v_lshlrev_b32 v10, 2, v10
    v_add_u32 v128, 161952, v10
    v_mov_b32 v127, 0x42800000
    v_cmp_eq_u32 vcc, 3, v9
    v_mov_b32 v10, 0x42600000
    s_nop 0
    v_cndmask_b32 v127, v127, v10, vcc
    v_cmp_eq_u32 vcc, 7, v9
    v_mov_b32 v10, 0x42540000
    s_nop 0
    v_cndmask_b32 v127, v127, v10, vcc
    s_getreg_b32 s97, hwreg(HW_REG_XCC_ID, 0, 4)
    s_or_b32 s97, s97, 0x80
    s_cmp_lg_u32 s36, 0
    s_cbranch_scc1 L_noxcc
    v_mov_b32 v9, s97
    s_lshl_b32 s47, s58, 4
    s_add_u32 s47, s47, s59
    v_mov_b32 v10, s47
    s_mov_b64 exec, 1
    buffer_store_byte v9, v10, s[64:67], 0 offen
    s_mov_b64 exec, -1
L_noxcc:
    s_mul_i32 s97, s97, 0x01010101
    v_lshrrev_b32 v9, 4, v1
    v_bfe_u32 v10, v1, 2, 2
    v_lshl_add_u32 v11, v9, 3, v10
    v_lshlrev_b32 v11, 7, v11
    v_lshrrev_b32 v10, 1, v10
    v_and_b32 v12, 1, v9
    v_lshl_or_b32 v10, v12, 1, v10
    v_xor_b32 v10, s36, v10
    v_lshl_add_u32 v11, v10, 5, v11
    v_and_b32 v10, 3, v1
    v_lshl_add_u32 v11, v10, 3, v11
    v_add_u32 v4, 71808, v11
    v_add_u32 v142, 137344, v11
    v_and_b32 v10, 15, v1
    v_mul_u32_u24 v11, 1056, v10
    v_lshl_add_u32 v6, v9, 4, v11
    s_lshl_b32 s46, s58, 4
    s_lshl_b32 s47, s36, 2
    s_add_u32 s46, s46, s47
    v_mov_b32 v134, s46
    s_lshl_b32 s47, s46, 7
    s_lshl_b32 s48, s59, 2
    s_add_u32 s47, s47, s48
    s_add_u32 s47, s47, 4198400
    v_lshl_add_u32 v137, v1, 7, s47
    s_lshl_b32 s46, s46, 14
    s_lshl_b32 s47, s59, 10
    s_add_u32 s46, s46, s47
    v_lshlrev_b32 v9, 14, v9
    v_lshlrev_b32 v10, 4, v10
    v_add3_u32 v7, v9, v10, s46
    v_mov_b32 v92, 0
    v_mov_b32 v93, 0
    v_mov_b32 v94, 0
    v_mov_b32 v95, 0
    v_mov_b32 v96, 0
    v_mov_b32 v97, 0
    v_mov_b32 v98, 0
    v_mov_b32 v99, 0
    v_mov_b32 v100, 0
    v_mov_b32 v101, 0
    v_mov_b32 v102, 0
    v_mov_b32 v103, 0
    v_mov_b32 v104, 0
    v_mov_b32 v105, 0
    v_mov_b32 v106, 0
    v_mov_b32 v107, 0
    v_mov_b32 v108, 0
    v_mov_b32 v109, 0
    v_mov_b32 v110, 0
    v_mov_b32 v111, 0
    v_mov_b32 v112, 0
    v_mov_b32 v113, 0
    v_mov_b32 v114, 0
    v_mov_b32 v115, 0
    v_mov_b32 v116, 0
    v_mov_b32 v117, 0
    v_mov_b32 v118, 0
    v_mov_b32 v119, 0
    v_mov_b32 v120, 0
    v_mov_b32 v121, 0
    v_mov_b32 v122, 0
    v_mov_b32 v123, 0
    s_waitcnt lgkmcnt(0)
    s_add_u32 s45, s44, 1
    v_mov_b32 v124, s45
    s_lshl_b32 s90, s50, 16
    s_and_b32 s91, s50, 0xffff0000
    s_lshl_b32 s92, s51, 16
    s_and_b32 s93, s51, 0xffff0000
    v_and_b32 v10, 2, v1
    v_cmp_eq_u32 vcc, 0, v10
    v_mov_b32 v10, s53
    v_mov_b32 v11, s52
    v_cndmask_b32 v125, v10, v11, vcc
    v_mov_b32 v10, s57
    v_mov_b32 v11, s56
    v_cndmask_b32 v126, v10, v11, vcc
    v_and_b32 v10, 1, v1
    v_cmp_eq_u32 vcc, 0, v10
    v_lshlrev_b32 v10, 16, v125
    v_and_b32 v11, 0xffff0000, v125
    v_cndmask_b32 v125, v11, v10, vcc
    v_lshlrev_b32 v10, 16, v126
    v_and_b32 v11, 0xffff0000, v126
    v_cndmask_b32 v126, v11, v10, vcc
    s_mov_b32 s100, 200000
    s_mov_b32 s3, 0x3b04eedd
    s_mov_b32 s98, 0xbdd2d3e8
    s_mov_b32 s99, s98
    v_mov_b32 v138, 0xc0135761
    v_mov_b32 v139, v138
    v_mov_b32 v140, 0x3727c5ac
    s_barrier
    ds_read_b64_tr_b16 v[12:13], v4 offset:0
    ds_read_b64_tr_b16 v[14:15], v4 offset:512
    ds_read_b128 v[28:31], v6 offset:0
    ds_read_b128 v[32:35], v6 offset:128
    ds_read_b128 v[36:39], v6 offset:256
    ds_read_b128 v[40:43], v6 offset:384
    ds_read_b128 v[44:47], v6 offset:512
    ds_read_b128 v[48:51], v6 offset:640
    ds_read_b128 v[52:55], v6 offset:768
    ds_read_b128 v[56:59], v6 offset:896
    ds_read_b64_tr_b16 v[16:17], v4 offset:4096
    ds_read_b64_tr_b16 v[18:19], v4 offset:4608
    s_waitcnt lgkmcnt(2)
    v_mfma_f32_16x16x32_bf16 v[92:95], v[12:15], v[28:31], v[92:95]
    ds_read_b64_tr_b16 v[20:21], v4 offset:8192
    v_mfma_f32_16x16x32_bf16 v[96:99], v[12:15], v[32:35], v[96:99]
    ds_read_b64_tr_b16 v[22:23], v4 offset:8704
    v_mfma_f32_16x16x32_bf16 v[100:103], v[12:15], v[36:39], v[100:103]
    ds_read_b128 v[60:63], v6 offset:1056
    v_mfma_f32_16x16x32_bf16 v[104:107], v[12:15], v[40:43], v[104:107]
    ds_read_b128 v[64:67], v6 offset:1184
    s_cmp_lg_u32 s101, 1
    s_cbranch_scc1 L_t0
    s_mov_b32 s39, 32768
    buffer_load_dword v133, v5, s[24:27], s39 offen
L_t0:
    v_mfma_f32_16x16x32_bf16 v[108:111], v[12:15], v[44:47], v[108:111]
    v_mfma_f32_16x16x32_bf16 v[112:115], v[12:15], v[48:51], v[112:115]
    v_mfma_f32_16x16x32_bf16 v[116:119], v[12:15], v[52:55], v[116:119]
    v_mfma_f32_16x16x32_bf16 v[120:123], v[12:15], v[56:59], v[120:123]
    s_waitcnt lgkmcnt(1)
    v_mfma_f32_16x16x32_bf16 v[92:95], v[16:19], v[32:35], v[92:95]
    ds_read_b64_tr_b16 v[24:25], v4 offset:12288
    v_mfma_f32_16x16x32_bf16 v[96:99], v[16:19], v[36:39], v[96:99]
    ds_read_b64_tr_b16 v[26:27], v4 offset:12800
    v_mfma_f32_16x16x32_bf16 v[100:103], v[16:19], v[40:43], v[100:103]
    ds_read_b128 v[68:71], v6 offset:1312
    v_mfma_f32_16x16x32_bf16 v[104:107], v[16:19], v[44:47], v[104:107]
    ds_read_b128 v[72:75], v6 offset:1440
    s_cmp_lg_u32 s101, 2
    s_cbranch_scc1 L_t1
    s_mov_b32 s39, 65536
    buffer_load_dword v133, v5, s[24:27], s39 offen
L_t1:
    v_mfma_f32_16x16x32_bf16 v[108:111], v[16:19], v[48:51], v[108:111]
    v_mfma_f32_16x16x32_bf16 v[112:115], v[16:19], v[52:55], v[112:115]
    v_mfma_f32_16x16x32_bf16 v[116:119], v[16:19], v[56:59], v[116:119]
    v_mfma_f32_16x16x32_bf16 v[120:123], v[16:19], v[60:63], v[120:123]
    s_barrier
    s_waitcnt lgkmcnt(4)
    v_mfma_f32_16x16x32_bf16 v[92:95], v[20:23], v[36:39], v[92:95]
    ds_read_b64_tr_b16 v[12:13], v4 offset:16384
    v_mfma_f32_16x16x32_bf16 v[96:99], v[20:23], v[40:43], v[96:99]
    ds_read_b64_tr_b16 v[14:15], v4 offset:16896
    v_mfma_f32_16x16x32_bf16 v[100:103], v[20:23], v[44:47], v[100:103]
    ds_read_b128 v[76:79], v6 offset:1568
    v_mfma_f32_16x16x32_bf16 v[104:107], v[20:23], v[48:51], v[104:107]
    ds_read_b128 v[80:83], v6 offset:1696
    v_mfma_f32_16x16x32_bf16 v[108:111], v[20:23], v[52:55], v[108:111]
    v_mfma_f32_16x16x32_bf16 v[112:115], v[20:23], v[56:59], v[112:115]
    v_mfma_f32_16x16x32_bf16 v[116:119], v[20:23], v[60:63], v[116:119]
    v_mfma_f32_16x16x32_bf16 v[120:123], v[20:23], v[64:67], v[120:123]
    s_waitcnt lgkmcnt(5)
    v_mfma_f32_16x16x32_bf16 v[92:95], v[24:27], v[40:43], v[92:95]
    ds_read_b64_tr_b16 v[16:17], v4 offset:20480
    v_mfma_f32_16x16x32_bf16 v[96:99], v[24:27], v[44:47], v[96:99]
    ds_read_b64_tr_b16 v[18:19], v4 offset:20992
    v_mfma_f32_16x16x32_bf16 v[100:103], v[24:27], v[48:51], v[100:103]
    ds_read_b128 v[84:87], v6 offset:1824
    v_mfma_f32_16x16x32_bf16 v[104:107], v[24:27], v[52:55], v[104:107]
    ds_read_b128 v[88:91], v6 offset:64
    s_cmp_lg_u32 s101, 3
    s_cbranch_scc1 L_t2
    s_mov_b32 s39, 98304
    buffer_load_dword v133, v5, s[24:27], s39 offen
L_t2:
    v_mfma_f32_16x16x32_bf16 v[108:111], v[24:27], v[56:59], v[108:111]
    v_mfma_f32_16x16x32_bf16 v[112:115], v[24:27], v[60:63], v[112:115]
    v_mfma_f32_16x16x32_bf16 v[116:119], v[24:27], v[64:67], v[116:119]
    v_mfma_f32_16x16x32_bf16 v[120:123], v[24:27], v[68:71], v[120:123]
    s_barrier
    s_waitcnt lgkmcnt(6)
    v_mfma_f32_16x16x32_bf16 v[92:95], v[12:15], v[44:47], v[92:95]
    ds_read_b64_tr_b16 v[20:21], v4 offset:24576
    v_mfma_f32_16x16x32_bf16 v[96:99], v[12:15], v[48:51], v[96:99]
    ds_read_b64_tr_b16 v[22:23], v4 offset:25088
    v_mfma_f32_16x16x32_bf16 v[100:103], v[12:15], v[52:55], v[100:103]
    ds_read_b128 v[28:31], v6 offset:192
    v_mfma_f32_16x16x32_bf16 v[104:107], v[12:15], v[56:59], v[104:107]
    ds_read_b128 v[32:35], v6 offset:320
    v_mfma_f32_16x16x32_bf16 v[108:111], v[12:15], v[60:63], v[108:111]
    v_mfma_f32_16x16x32_bf16 v[112:115], v[12:15], v[64:67], v[112:115]
    v_mfma_f32_16x16x32_bf16 v[116:119], v[12:15], v[68:71], v[116:119]
    v_mfma_f32_16x16x32_bf16 v[120:123], v[12:15], v[72:75], v[120:123]
    s_waitcnt lgkmcnt(6)
    v_mfma_f32_16x16x32_bf16 v[92:95], v[16:19], v[48:51], v[92:95]
    ds_read_b64_tr_b16 v[24:25], v4 offset:28672
    v_mfma_f32_16x16x32_bf16 v[96:99], v[16:19], v[52:55], v[96:99]
    ds_read_b64_tr_b16 v[26:27], v4 offset:29184
    v_mfma_f32_16x16x32_bf16 v[100:103], v[16:19], v[56:59], v[100:103]
    ds_read_b128 v[36:39], v6 offset:448
    v_mfma_f32_16x16x32_bf16 v[104:107], v[16:19], v[60:63], v[104:107]
    ds_read_b128 v[40:43], v6 offset:576
    v_mfma_f32_16x16x32_bf16 v[108:111], v[16:19], v[64:67], v[108:111]
    v_mfma_f32_16x16x32_bf16 v[112:115], v[16:19], v[68:71], v[112:115]
    v_mfma_f32_16x16x32_bf16 v[116:119], v[16:19], v[72:75], v[116:119]
    v_mfma_f32_16x16x32_bf16 v[120:123], v[16:19], v[76:79], v[120:123]
    s_barrier
    s_waitcnt lgkmcnt(6)
    v_mfma_f32_16x16x32_bf16 v[92:95], v[20:23], v[52:55], v[92:95]
    ds_read_b64_tr_b16 v[12:13], v4 offset:32768
    v_mfma_f32_16x16x32_bf16 v[96:99], v[20:23], v[56:59], v[96:99]
    ds_read_b64_tr_b16 v[14:15], v4 offset:33280
    v_mfma_f32_16x16x32_bf16 v[100:103], v[20:23], v[60:63], v[100:103]
    ds_read_b128 v[44:47], v6 offset:704
    v_mfma_f32_16x16x32_bf16 v[104:107], v[20:23], v[64:67], v[104:107]
    ds_read_b128 v[48:51], v6 offset:832
    v_mfma_f32_16x16x32_bf16 v[108:111], v[20:23], v[68:71], v[108:111]
    v_mfma_f32_16x16x32_bf16 v[112:115], v[20:23], v[72:75], v[112:115]
    v_mfma_f32_16x16x32_bf16 v[116:119], v[20:23], v[76:79], v[116:119]
    v_mfma_f32_16x16x32_bf16 v[120:123], v[20:23], v[80:83], v[120:123]
    s_waitcnt lgkmcnt(6)
    v_mfma_f32_16x16x32_bf16 v[92:95], v[24:27], v[56:59], v[92:95]
    ds_read_b64_tr_b16 v[16:17], v4 offset:36864
    v_mfma_f32_16x16x32_bf16 v[96:99], v[24:27], v[60:63], v[96:99]
    ds_read_b64_tr_b16 v[18:19], v4 offset:37376
    v_mfma_f32_16x16x32_bf16 v[100:103], v[24:27], v[64:67], v[100:103]
    ds_read_b128 v[52:55], v6 offset:960
    v_mfma_f32_16x16x32_bf16 v[104:107], v[24:27], v[68:71], v[104:107]
    s_cmp_lg_u32 s101, 0
    s_cbranch_scc1 L_t3
    s_mov_b32 s39, 524288
    buffer_load_dword v133, v5, s[24:27], s39 offen
L_t3:
    v_mfma_f32_16x16x32_bf16 v[108:111], v[24:27], v[72:75], v[108:111]
    v_mfma_f32_16x16x32_bf16 v[112:115], v[24:27], v[76:79], v[112:115]
    v_mfma_f32_16x16x32_bf16 v[116:119], v[24:27], v[80:83], v[116:119]
    v_mfma_f32_16x16x32_bf16 v[120:123], v[24:27], v[84:87], v[120:123]
    s_barrier
    s_waitcnt lgkmcnt(0)
    v_mfma_f32_16x16x32_bf16 v[92:95], v[12:15], v[88:91], v[92:95]
    ds_read_b64_tr_b16 v[20:21], v4 offset:40960
    v_mfma_f32_16x16x32_bf16 v[96:99], v[12:15], v[28:31], v[96:99]
    ds_read_b64_tr_b16 v[22:23], v4 offset:41472
    v_mfma_f32_16x16x32_bf16 v[100:103], v[12:15], v[32:35], v[100:103]
    ds_read_b128 v[56:59], v6 offset:1120
    v_mfma_f32_16x16x32_bf16 v[104:107], v[12:15], v[36:39], v[104:107]
    ds_read_b128 v[60:63], v6 offset:1248
    v_mfma_f32_16x16x32_bf16 v[108:111], v[12:15], v[40:43], v[108:111]
    v_mfma_f32_16x16x32_bf16 v[112:115], v[12:15], v[44:47], v[112:115]
    v_mfma_f32_16x16x32_bf16 v[116:119], v[12:15], v[48:51], v[116:119]
    v_mfma_f32_16x16x32_bf16 v[120:123], v[12:15], v[52:55], v[120:123]
    s_waitcnt lgkmcnt(1)
    v_mfma_f32_16x16x32_bf16 v[92:95], v[16:19], v[28:31], v[92:95]
    ds_read_b64_tr_b16 v[24:25], v4 offset:45056
    v_mfma_f32_16x16x32_bf16 v[96:99], v[16:19], v[32:35], v[96:99]
    ds_read_b64_tr_b16 v[26:27], v4 offset:45568
    v_mfma_f32_16x16x32_bf16 v[100:103], v[16:19], v[36:39], v[100:103]
    ds_read_b128 v[64:67], v6 offset:1376
    v_mfma_f32_16x16x32_bf16 v[104:107], v[16:19], v[40:43], v[104:107]
    ds_read_b128 v[68:71], v6 offset:1504
    v_mfma_f32_16x16x32_bf16 v[108:111], v[16:19], v[44:47], v[108:111]
    v_mfma_f32_16x16x32_bf16 v[112:115], v[16:19], v[48:51], v[112:115]
    v_mfma_f32_16x16x32_bf16 v[116:119], v[16:19], v[52:55], v[116:119]
    v_mfma_f32_16x16x32_bf16 v[120:123], v[16:19], v[56:59], v[120:123]
    s_waitcnt lgkmcnt(4)
    v_mfma_f32_16x16x32_bf16 v[92:95], v[20:23], v[32:35], v[92:95]
    ds_read_b64_tr_b16 v[12:13], v4 offset:49152
    v_mfma_f32_16x16x32_bf16 v[96:99], v[20:23], v[36:39], v[96:99]
    ds_read_b64_tr_b16 v[14:15], v4 offset:49664
    v_mfma_f32_16x16x32_bf16 v[100:103], v[20:23], v[40:43], v[100:103]
    ds_read_b128 v[72:75], v6 offset:1632
    v_mfma_f32_16x16x32_bf16 v[104:107], v[20:23], v[44:47], v[104:107]
    ds_read_b128 v[76:79], v6 offset:1760
    v_mfma_f32_16x16x32_bf16 v[108:111], v[20:23], v[48:51], v[108:111]
    v_mfma_f32_16x16x32_bf16 v[112:115], v[20:23], v[52:55], v[112:115]
    v_mfma_f32_16x16x32_bf16 v[116:119], v[20:23], v[56:59], v[116:119]
    v_mfma_f32_16x16x32_bf16 v[120:123], v[20:23], v[60:63], v[120:123]
    s_waitcnt lgkmcnt(5)
    v_mfma_f32_16x16x32_bf16 v[92:95], v[24:27], v[36:39], v[92:95]
    ds_read_b64_tr_b16 v[16:17], v4 offset:53248
    v_mfma_f32_16x16x32_bf16 v[96:99], v[24:27], v[40:43], v[96:99]
    ds_read_b64_tr_b16 v[18:19], v4 offset:53760
    v_mfma_f32_16x16x32_bf16 v[100:103], v[24:27], v[44:47], v[100:103]
    ds_read_b128 v[80:83], v6 offset:1888
    v_mfma_f32_16x16x32_bf16 v[104:107], v[24:27], v[48:51], v[104:107]
    v_mfma_f32_16x16x32_bf16 v[108:111], v[24:27], v[52:55], v[108:111]
    v_mfma_f32_16x16x32_bf16 v[112:115], v[24:27], v[56:59], v[112:115]
    v_mfma_f32_16x16x32_bf16 v[116:119], v[24:27], v[60:63], v[116:119]
    v_mfma_f32_16x16x32_bf16 v[120:123], v[24:27], v[64:67], v[120:123]
    s_barrier
    s_waitcnt lgkmcnt(5)
    v_mfma_f32_16x16x32_bf16 v[92:95], v[12:15], v[40:43], v[92:95]
    ds_read_b64_tr_b16 v[20:21], v4 offset:57344
    v_mfma_f32_16x16x32_bf16 v[96:99], v[12:15], v[44:47], v[96:99]
    ds_read_b64_tr_b16 v[22:23], v4 offset:57856
    v_mfma_f32_16x16x32_bf16 v[100:103], v[12:15], v[48:51], v[100:103]
    ds_read_b128 v[84:87], v6 offset:17952
    v_mfma_f32_16x16x32_bf16 v[104:107], v[12:15], v[52:55], v[104:107]
    ds_read_b128 v[88:91], v6 offset:18080
    v_mfma_f32_16x16x32_bf16 v[108:111], v[12:15], v[56:59], v[108:111]
    v_mfma_f32_16x16x32_bf16 v[112:115], v[12:15], v[60:63], v[112:115]
    v_mfma_f32_16x16x32_bf16 v[116:119], v[12:15], v[64:67], v[116:119]
    v_mfma_f32_16x16x32_bf16 v[120:123], v[12:15], v[68:71], v[120:123]
    s_waitcnt lgkmcnt(5)
    v_mfma_f32_16x16x32_bf16 v[92:95], v[16:19], v[44:47], v[92:95]
    ds_read_b64_tr_b16 v[24:25], v4 offset:61440
    v_mfma_f32_16x16x32_bf16 v[96:99], v[16:19], v[48:51], v[96:99]
    ds_read_b64_tr_b16 v[26:27], v4 offset:61952
    v_mfma_f32_16x16x32_bf16 v[100:103], v[16:19], v[52:55], v[100:103]
    ds_read_b128 v[28:31], v6 offset:18208
    v_mfma_f32_16x16x32_bf16 v[104:107], v[16:19], v[56:59], v[104:107]
    ds_read_b128 v[32:35], v6 offset:18336
    s_cmp_lg_u32 s101, 1
    s_cbranch_scc1 L_t4
    s_mov_b32 s39, 557056
    buffer_load_dword v133, v5, s[24:27], s39 offen
L_t4:
    v_mfma_f32_16x16x32_bf16 v[108:111], v[16:19], v[60:63], v[108:111]
    v_mfma_f32_16x16x32_bf16 v[112:115], v[16:19], v[64:67], v[112:115]
    v_mfma_f32_16x16x32_bf16 v[116:119], v[16:19], v[68:71], v[116:119]
    v_mfma_f32_16x16x32_bf16 v[120:123], v[16:19], v[72:75], v[120:123]
    s_waitcnt lgkmcnt(6)
    v_mfma_f32_16x16x32_bf16 v[92:95], v[20:23], v[48:51], v[92:95]
    ds_read_b64_tr_b16 v[12:13], v142 offset:0
    v_mfma_f32_16x16x32_bf16 v[96:99], v[20:23], v[52:55], v[96:99]
    ds_read_b64_tr_b16 v[14:15], v142 offset:512
    v_mfma_f32_16x16x32_bf16 v[100:103], v[20:23], v[56:59], v[100:103]
    ds_read_b128 v[36:39], v6 offset:18464
    v_mfma_f32_16x16x32_bf16 v[104:107], v[20:23], v[60:63], v[104:107]
    ds_read_b128 v[40:43], v6 offset:18592
    v_mfma_f32_16x16x32_bf16 v[108:111], v[20:23], v[64:67], v[108:111]
    v_mfma_f32_16x16x32_bf16 v[112:115], v[20:23], v[68:71], v[112:115]
    v_mfma_f32_16x16x32_bf16 v[116:119], v[20:23], v[72:75], v[116:119]
    v_mfma_f32_16x16x32_bf16 v[120:123], v[20:23], v[76:79], v[120:123]
    s_waitcnt lgkmcnt(6)
    v_mfma_f32_16x16x32_bf16 v[92:95], v[24:27], v[52:55], v[92:95]
    ds_read_b64_tr_b16 v[16:17], v142 offset:4096
    v_mfma_f32_16x16x32_bf16 v[96:99], v[24:27], v[56:59], v[96:99]
    ds_read_b64_tr_b16 v[18:19], v142 offset:4608
    v_mfma_f32_16x16x32_bf16 v[100:103], v[24:27], v[60:63], v[100:103]
    ds_read_b128 v[44:47], v6 offset:18720
    v_mfma_f32_16x16x32_bf16 v[104:107], v[24:27], v[64:67], v[104:107]
    ds_read_b128 v[48:51], v6 offset:18848
    v_mfma_f32_16x16x32_bf16 v[108:111], v[24:27], v[68:71], v[108:111]
    v_mfma_f32_16x16x32_bf16 v[112:115], v[24:27], v[72:75], v[112:115]
    v_mfma_f32_16x16x32_bf16 v[116:119], v[24:27], v[76:79], v[116:119]
    v_mfma_f32_16x16x32_bf16 v[120:123], v[24:27], v[80:83], v[120:123]
    s_barrier
    s_waitcnt lgkmcnt(0)
    v_mfma_f32_16x16x32_bf16 v[92:95], v[12:15], v[84:87], v[92:95]
    ds_read_b64_tr_b16 v[20:21], v142 offset:8192
    v_mfma_f32_16x16x32_bf16 v[96:99], v[12:15], v[88:91], v[96:99]
    ds_read_b64_tr_b16 v[22:23], v142 offset:8704
    v_mfma_f32_16x16x32_bf16 v[100:103], v[12:15], v[28:31], v[100:103]
    ds_read_b128 v[52:55], v6 offset:19008
    v_mfma_f32_16x16x32_bf16 v[104:107], v[12:15], v[32:35], v[104:107]
    ds_read_b128 v[56:59], v6 offset:19136
    v_mfma_f32_16x16x32_bf16 v[108:111], v[12:15], v[36:39], v[108:111]
    v_mfma_f32_16x16x32_bf16 v[112:115], v[12:15], v[40:43], v[112:115]
    v_mfma_f32_16x16x32_bf16 v[116:119], v[12:15], v[44:47], v[116:119]
    v_mfma_f32_16x16x32_bf16 v[120:123], v[12:15], v[48:51], v[120:123]
    s_waitcnt lgkmcnt(1)
    v_mfma_f32_16x16x32_bf16 v[92:95], v[16:19], v[88:91], v[92:95]
    ds_read_b64_tr_b16 v[24:25], v142 offset:12288
    v_mfma_f32_16x16x32_bf16 v[96:99], v[16:19], v[28:31], v[96:99]
    ds_read_b64_tr_b16 v[26:27], v142 offset:12800
    v_mfma_f32_16x16x32_bf16 v[100:103], v[16:19], v[32:35], v[100:103]
    ds_read_b128 v[60:63], v6 offset:19264
    v_mfma_f32_16x16x32_bf16 v[104:107], v[16:19], v[36:39], v[104:107]
    ds_read_b128 v[64:67], v6 offset:19392
    v_mfma_f32_16x16x32_bf16 v[108:111], v[16:19], v[40:43], v[108:111]
    v_mfma_f32_16x16x32_bf16 v[112:115], v[16:19], v[44:47], v[112:115]
    v_mfma_f32_16x16x32_bf16 v[116:119], v[16:19], v[48:51], v[116:119]
    v_mfma_f32_16x16x32_bf16 v[120:123], v[16:19], v[52:55], v[120:123]
    s_waitcnt lgkmcnt(4)
    v_mfma_f32_16x16x32_bf16 v[92:95], v[20:23], v[28:31], v[92:95]
    ds_read_b64_tr_b16 v[12:13], v142 offset:16384
    v_mfma_f32_16x16x32_bf16 v[96:99], v[20:23], v[32:35], v[96:99]
    ds_read_b64_tr_b16 v[14:15], v142 offset:16896
    v_mfma_f32_16x16x32_bf16 v[100:103], v[20:23], v[36:39], v[100:103]
    ds_read_b128 v[68:71], v6 offset:19520
    v_mfma_f32_16x16x32_bf16 v[104:107], v[20:23], v[40:43], v[104:107]
    ds_read_b128 v[72:75], v6 offset:19648
    v_mfma_f32_16x16x32_bf16 v[108:111], v[20:23], v[44:47], v[108:111]
    v_mfma_f32_16x16x32_bf16 v[112:115], v[20:23], v[48:51], v[112:115]
    v_mfma_f32_16x16x32_bf16 v[116:119], v[20:23], v[52:55], v[116:119]
    v_mfma_f32_16x16x32_bf16 v[120:123], v[20:23], v[56:59], v[120:123]
    s_waitcnt lgkmcnt(5)
    v_mfma_f32_16x16x32_bf16 v[92:95], v[24:27], v[32:35], v[92:95]
    ds_read_b64_tr_b16 v[16:17], v142 offset:20480
    v_mfma_f32_16x16x32_bf16 v[96:99], v[24:27], v[36:39], v[96:99]
    ds_read_b64_tr_b16 v[18:19], v142 offset:20992
    v_mfma_f32_16x16x32_bf16 v[100:103], v[24:27], v[40:43], v[100:103]
    ds_read_b128 v[76:79], v6 offset:19776
    v_mfma_f32_16x16x32_bf16 v[104:107], v[24:27], v[44:47], v[104:107]
    ds_read_b128 v[80:83], v6 offset:18016
    v_mfma_f32_16x16x32_bf16 v[108:111], v[24:27], v[48:51], v[108:111]
    v_mfma_f32_16x16x32_bf16 v[112:115], v[24:27], v[52:55], v[112:115]
    v_mfma_f32_16x16x32_bf16 v[116:119], v[24:27], v[56:59], v[116:119]
    v_mfma_f32_16x16x32_bf16 v[120:123], v[24:27], v[60:63], v[120:123]
    s_barrier
    s_waitcnt lgkmcnt(6)
    v_mfma_f32_16x16x32_bf16 v[92:95], v[12:15], v[36:39], v[92:95]
    ds_read_b64_tr_b16 v[20:21], v4 offset:0
    v_mfma_f32_16x16x32_bf16 v[96:99], v[12:15], v[40:43], v[96:99]
    ds_read_b64_tr_b16 v[22:23], v4 offset:512
    v_mfma_f32_16x16x32_bf16 v[100:103], v[12:15], v[44:47], v[100:103]
    ds_read_b128 v[84:87], v6 offset:18144
    v_mfma_f32_16x16x32_bf16 v[104:107], v[12:15], v[48:51], v[104:107]
    ds_read_b128 v[88:91], v6 offset:18272
    s_cmp_lg_u32 s101, 2
    s_cbranch_scc1 L_t5
    s_mov_b32 s39, 589824
    buffer_load_dword v133, v5, s[24:27], s39 offen
L_t5:
    v_mfma_f32_16x16x32_bf16 v[108:111], v[12:15], v[52:55], v[108:111]
    v_mfma_f32_16x16x32_bf16 v[112:115], v[12:15], v[56:59], v[112:115]
    v_mfma_f32_16x16x32_bf16 v[116:119], v[12:15], v[60:63], v[116:119]
    v_mfma_f32_16x16x32_bf16 v[120:123], v[12:15], v[64:67], v[120:123]
    s_waitcnt lgkmcnt(6)
    v_mfma_f32_16x16x32_bf16 v[92:95], v[16:19], v[40:43], v[92:95]
    ds_read_b64_tr_b16 v[24:25], v4 offset:4096
    v_mfma_f32_16x16x32_bf16 v[96:99], v[16:19], v[44:47], v[96:99]
    ds_read_b64_tr_b16 v[26:27], v4 offset:4608
    v_mfma_f32_16x16x32_bf16 v[100:103], v[16:19], v[48:51], v[100:103]
    ds_read_b128 v[28:31], v6 offset:18400
    v_mfma_f32_16x16x32_bf16 v[104:107], v[16:19], v[52:55], v[104:107]
    ds_read_b128 v[32:35], v6 offset:18528
    v_mfma_f32_16x16x32_bf16 v[108:111], v[16:19], v[56:59], v[108:111]
    v_mfma_f32_16x16x32_bf16 v[112:115], v[16:19], v[60:63], v[112:115]
    v_mfma_f32_16x16x32_bf16 v[116:119], v[16:19], v[64:67], v[116:119]
    v_mfma_f32_16x16x32_bf16 v[120:123], v[16:19], v[68:71], v[120:123]
    s_waitcnt lgkmcnt(6)
    v_mfma_f32_16x16x32_bf16 v[92:95], v[20:23], v[44:47], v[92:95]
    ds_read_b64_tr_b16 v[12:13], v4 offset:8192
    v_mfma_f32_16x16x32_bf16 v[96:99], v[20:23], v[48:51], v[96:99]
    ds_read_b64_tr_b16 v[14:15], v4 offset:8704
    v_mfma_f32_16x16x32_bf16 v[100:103], v[20:23], v[52:55], v[100:103]
    ds_read_b128 v[36:39], v6 offset:18656
    v_mfma_f32_16x16x32_bf16 v[104:107], v[20:23], v[56:59], v[104:107]
    ds_read_b128 v[40:43], v6 offset:18784
    v_mfma_f32_16x16x32_bf16 v[108:111], v[20:23], v[60:63], v[108:111]
    v_mfma_f32_16x16x32_bf16 v[112:115], v[20:23], v[64:67], v[112:115]
    v_mfma_f32_16x16x32_bf16 v[116:119], v[20:23], v[68:71], v[116:119]
    v_mfma_f32_16x16x32_bf16 v[120:123], v[20:23], v[72:75], v[120:123]
    s_waitcnt lgkmcnt(6)
    v_mfma_f32_16x16x32_bf16 v[92:95], v[24:27], v[48:51], v[92:95]
    ds_read_b64_tr_b16 v[16:17], v4 offset:12288
    v_mfma_f32_16x16x32_bf16 v[96:99], v[24:27], v[52:55], v[96:99]
    ds_read_b64_tr_b16 v[18:19], v4 offset:12800
    v_mfma_f32_16x16x32_bf16 v[100:103], v[24:27], v[56:59], v[100:103]
    ds_read_b128 v[44:47], v6 offset:18912
    v_mfma_f32_16x16x32_bf16 v[104:107], v[24:27], v[60:63], v[104:107]
    v_mfma_f32_16x16x32_bf16 v[108:111], v[24:27], v[64:67], v[108:111]
    v_mfma_f32_16x16x32_bf16 v[112:115], v[24:27], v[68:71], v[112:115]
    v_mfma_f32_16x16x32_bf16 v[116:119], v[24:27], v[72:75], v[116:119]
    v_mfma_f32_16x16x32_bf16 v[120:123], v[24:27], v[76:79], v[120:123]
    s_barrier
    s_waitcnt lgkmcnt(0)
    v_mfma_f32_16x16x32_bf16 v[92:95], v[12:15], v[80:83], v[92:95]
    ds_read_b64_tr_b16 v[20:21], v4 offset:16384
    v_mfma_f32_16x16x32_bf16 v[96:99], v[12:15], v[84:87], v[96:99]
    ds_read_b64_tr_b16 v[22:23], v4 offset:16896
    v_mfma_f32_16x16x32_bf16 v[100:103], v[12:15], v[88:91], v[100:103]
    ds_read_b128 v[48:51], v6 offset:19072
    v_mfma_f32_16x16x32_bf16 v[104:107], v[12:15], v[28:31], v[104:107]
    ds_read_b128 v[52:55], v6 offset:19200
    v_mfma_f32_16x16x32_bf16 v[108:111], v[12:15], v[32:35], v[108:111]
    v_mfma_f32_16x16x32_bf16 v[112:115], v[12:15], v[36:39], v[112:115]
    v_mfma_f32_16x16x32_bf16 v[116:119], v[12:15], v[40:43], v[116:119]
    v_mfma_f32_16x16x32_bf16 v[120:123], v[12:15], v[44:47], v[120:123]
    s_waitcnt lgkmcnt(1)
    v_mfma_f32_16x16x32_bf16 v[92:95], v[16:19], v[84:87], v[92:95]
    ds_read_b64_tr_b16 v[24:25], v4 offset:20480
    v_mfma_f32_16x16x32_bf16 v[96:99], v[16:19], v[88:91], v[96:99]
    ds_read_b64_tr_b16 v[26:27], v4 offset:20992
    v_mfma_f32_16x16x32_bf16 v[100:103], v[16:19], v[28:31], v[100:103]
    ds_read_b128 v[56:59], v6 offset:19328
    v_mfma_f32_16x16x32_bf16 v[104:107], v[16:19], v[32:35], v[104:107]
    ds_read_b128 v[60:63], v6 offset:19456
    v_mfma_f32_16x16x32_bf16 v[108:111], v[16:19], v[36:39], v[108:111]
    v_mfma_f32_16x16x32_bf16 v[112:115], v[16:19], v[40:43], v[112:115]
    v_mfma_f32_16x16x32_bf16 v[116:119], v[16:19], v[44:47], v[116:119]
    v_mfma_f32_16x16x32_bf16 v[120:123], v[16:19], v[48:51], v[120:123]
    s_waitcnt lgkmcnt(4)
    v_mfma_f32_16x16x32_bf16 v[92:95], v[20:23], v[88:91], v[92:95]
    ds_read_b64_tr_b16 v[12:13], v4 offset:24576
    v_mfma_f32_16x16x32_bf16 v[96:99], v[20:23], v[28:31], v[96:99]
    ds_read_b64_tr_b16 v[14:15], v4 offset:25088
    v_mfma_f32_16x16x32_bf16 v[100:103], v[20:23], v[32:35], v[100:103]
    ds_read_b128 v[64:67], v6 offset:19584
    v_mfma_f32_16x16x32_bf16 v[104:107], v[20:23], v[36:39], v[104:107]
    ds_read_b128 v[68:71], v6 offset:19712
    v_mfma_f32_16x16x32_bf16 v[108:111], v[20:23], v[40:43], v[108:111]
    v_mfma_f32_16x16x32_bf16 v[112:115], v[20:23], v[44:47], v[112:115]
    v_mfma_f32_16x16x32_bf16 v[116:119], v[20:23], v[48:51], v[116:119]
    v_mfma_f32_16x16x32_bf16 v[120:123], v[20:23], v[52:55], v[120:123]
    s_waitcnt lgkmcnt(5)
    v_mfma_f32_16x16x32_bf16 v[92:95], v[24:27], v[28:31], v[92:95]
    ds_read_b64_tr_b16 v[16:17], v4 offset:28672
    v_mfma_f32_16x16x32_bf16 v[96:99], v[24:27], v[32:35], v[96:99]
    ds_read_b64_tr_b16 v[18:19], v4 offset:29184
    v_mfma_f32_16x16x32_bf16 v[100:103], v[24:27], v[36:39], v[100:103]
    ds_read_b128 v[72:75], v6 offset:19840
    v_mfma_f32_16x16x32_bf16 v[104:107], v[24:27], v[40:43], v[104:107]
    s_cmp_lg_u32 s101, 3
    s_cbranch_scc1 L_t6
    s_mov_b32 s39, 622592
    buffer_load_dword v133, v5, s[24:27], s39 offen
L_t6:
    v_mfma_f32_16x16x32_bf16 v[108:111], v[24:27], v[44:47], v[108:111]
    v_mfma_f32_16x16x32_bf16 v[112:115], v[24:27], v[48:51], v[112:115]
    v_mfma_f32_16x16x32_bf16 v[116:119], v[24:27], v[52:55], v[116:119]
    v_mfma_f32_16x16x32_bf16 v[120:123], v[24:27], v[56:59], v[120:123]
    s_barrier
    s_waitcnt lgkmcnt(5)
    v_mfma_f32_16x16x32_bf16 v[92:95], v[12:15], v[32:35], v[92:95]
    ds_read_b64_tr_b16 v[20:21], v4 offset:32768
    v_mfma_f32_16x16x32_bf16 v[96:99], v[12:15], v[36:39], v[96:99]
    ds_read_b64_tr_b16 v[22:23], v4 offset:33280
    v_mfma_f32_16x16x32_bf16 v[100:103], v[12:15], v[40:43], v[100:103]
    ds_read_b128 v[76:79], v6 offset:35904
    v_mfma_f32_16x16x32_bf16 v[104:107], v[12:15], v[44:47], v[104:107]
    ds_read_b128 v[80:83], v6 offset:36032
    v_mfma_f32_16x16x32_bf16 v[108:111], v[12:15], v[48:51], v[108:111]
    v_mfma_f32_16x16x32_bf16 v[112:115], v[12:15], v[52:55], v[112:115]
    v_mfma_f32_16x16x32_bf16 v[116:119], v[12:15], v[56:59], v[116:119]
    v_mfma_f32_16x16x32_bf16 v[120:123], v[12:15], v[60:63], v[120:123]
    s_waitcnt lgkmcnt(5)
    v_mfma_f32_16x16x32_bf16 v[92:95], v[16:19], v[36:39], v[92:95]
    ds_read_b64_tr_b16 v[24:25], v4 offset:36864
    v_mfma_f32_16x16x32_bf16 v[96:99], v[16:19], v[40:43], v[96:99]
    ds_read_b64_tr_b16 v[26:27], v4 offset:37376
    v_mfma_f32_16x16x32_bf16 v[100:103], v[16:19], v[44:47], v[100:103]
    ds_read_b128 v[84:87], v6 offset:36160
    v_mfma_f32_16x16x32_bf16 v[104:107], v[16:19], v[48:51], v[104:107]
    ds_read_b128 v[88:91], v6 offset:36288
    v_mfma_f32_16x16x32_bf16 v[108:111], v[16:19], v[52:55], v[108:111]
    v_mfma_f32_16x16x32_bf16 v[112:115], v[16:19], v[56:59], v[112:115]
    v_mfma_f32_16x16x32_bf16 v[116:119], v[16:19], v[60:63], v[116:119]
    v_mfma_f32_16x16x32_bf16 v[120:123], v[16:19], v[64:67], v[120:123]
    s_waitcnt lgkmcnt(6)
    v_mfma_f32_16x16x32_bf16 v[92:95], v[20:23], v[40:43], v[92:95]
    ds_read_b64_tr_b16 v[12:13], v4 offset:40960
    v_mfma_f32_16x16x32_bf16 v[96:99], v[20:23], v[44:47], v[96:99]
    ds_read_b64_tr_b16 v[14:15], v4 offset:41472
    v_mfma_f32_16x16x32_bf16 v[100:103], v[20:23], v[48:51], v[100:103]
    ds_read_b128 v[28:31], v6 offset:36416
    v_mfma_f32_16x16x32_bf16 v[104:107], v[20:23], v[52:55], v[104:107]
    ds_read_b128 v[32:35], v6 offset:36544
    v_mfma_f32_16x16x32_bf16 v[108:111], v[20:23], v[56:59], v[108:111]
    v_mfma_f32_16x16x32_bf16 v[112:115], v[20:23], v[60:63], v[112:115]
    v_mfma_f32_16x16x32_bf16 v[116:119], v[20:23], v[64:67], v[116:119]
    v_mfma_f32_16x16x32_bf16 v[120:123], v[20:23], v[68:71], v[120:123]
    s_waitcnt lgkmcnt(6)
    v_mfma_f32_16x16x32_bf16 v[92:95], v[24:27], v[44:47], v[92:95]
    ds_read_b64_tr_b16 v[16:17], v4 offset:45056
    v_mfma_f32_16x16x32_bf16 v[96:99], v[24:27], v[48:51], v[96:99]
    ds_read_b64_tr_b16 v[18:19], v4 offset:45568
    v_mfma_f32_16x16x32_bf16 v[100:103], v[24:27], v[52:55], v[100:103]
    ds_read_b128 v[36:39], v6 offset:36672
    v_mfma_f32_16x16x32_bf16 v[104:107], v[24:27], v[56:59], v[104:107]
    ds_read_b128 v[40:43], v6 offset:36800
    v_mfma_f32_16x16x32_bf16 v[108:111], v[24:27], v[60:63], v[108:111]
    v_mfma_f32_16x16x32_bf16 v[112:115], v[24:27], v[64:67], v[112:115]
    v_mfma_f32_16x16x32_bf16 v[116:119], v[24:27], v[68:71], v[116:119]
    v_mfma_f32_16x16x32_bf16 v[120:123], v[24:27], v[72:75], v[120:123]
    s_barrier
    s_waitcnt lgkmcnt(0)
    v_mfma_f32_16x16x32_bf16 v[92:95], v[12:15], v[76:79], v[92:95]
    ds_read_b64_tr_b16 v[20:21], v4 offset:49152
    v_mfma_f32_16x16x32_bf16 v[96:99], v[12:15], v[80:83], v[96:99]
    ds_read_b64_tr_b16 v[22:23], v4 offset:49664
    v_mfma_f32_16x16x32_bf16 v[100:103], v[12:15], v[84:87], v[100:103]
    ds_read_b128 v[44:47], v6 offset:36960
    v_mfma_f32_16x16x32_bf16 v[104:107], v[12:15], v[88:91], v[104:107]
    ds_read_b128 v[48:51], v6 offset:37088
    v_mfma_f32_16x16x32_bf16 v[108:111], v[12:15], v[28:31], v[108:111]
    v_mfma_f32_16x16x32_bf16 v[112:115], v[12:15], v[32:35], v[112:115]
    v_mfma_f32_16x16x32_bf16 v[116:119], v[12:15], v[36:39], v[116:119]
    v_mfma_f32_16x16x32_bf16 v[120:123], v[12:15], v[40:43], v[120:123]
    s_waitcnt lgkmcnt(1)
    v_mfma_f32_16x16x32_bf16 v[92:95], v[16:19], v[80:83], v[92:95]
    ds_read_b64_tr_b16 v[24:25], v4 offset:53248
    v_mfma_f32_16x16x32_bf16 v[96:99], v[16:19], v[84:87], v[96:99]
    ds_read_b64_tr_b16 v[26:27], v4 offset:53760
    v_mfma_f32_16x16x32_bf16 v[100:103], v[16:19], v[88:91], v[100:103]
    ds_read_b128 v[52:55], v6 offset:37216
    v_mfma_f32_16x16x32_bf16 v[104:107], v[16:19], v[28:31], v[104:107]
    ds_read_b128 v[56:59], v6 offset:37344
    v_mfma_f32_16x16x32_bf16 v[108:111], v[16:19], v[32:35], v[108:111]
    v_mfma_f32_16x16x32_bf16 v[112:115], v[16:19], v[36:39], v[112:115]
    v_mfma_f32_16x16x32_bf16 v[116:119], v[16:19], v[40:43], v[116:119]
    v_mfma_f32_16x16x32_bf16 v[120:123], v[16:19], v[44:47], v[120:123]
    s_waitcnt lgkmcnt(4)
    v_mfma_f32_16x16x32_bf16 v[92:95], v[20:23], v[84:87], v[92:95]
    ds_read_b64_tr_b16 v[12:13], v4 offset:57344
    v_mfma_f32_16x16x32_bf16 v[96:99], v[20:23], v[88:91], v[96:99]
    ds_read_b64_tr_b16 v[14:15], v4 offset:57856
    v_mfma_f32_16x16x32_bf16 v[100:103], v[20:23], v[28:31], v[100:103]
    ds_read_b128 v[60:63], v6 offset:37472
    v_mfma_f32_16x16x32_bf16 v[104:107], v[20:23], v[32:35], v[104:107]
    ds_read_b128 v[64:67], v6 offset:37600
    v_mfma_f32_16x16x32_bf16 v[108:111], v[20:23], v[36:39], v[108:111]
    v_mfma_f32_16x16x32_bf16 v[112:115], v[20:23], v[40:43], v[112:115]
    v_mfma_f32_16x16x32_bf16 v[116:119], v[20:23], v[44:47], v[116:119]
    v_mfma_f32_16x16x32_bf16 v[120:123], v[20:23], v[48:51], v[120:123]
    s_waitcnt lgkmcnt(5)
    v_mfma_f32_16x16x32_bf16 v[92:95], v[24:27], v[88:91], v[92:95]
    ds_read_b64_tr_b16 v[16:17], v4 offset:61440
    v_mfma_f32_16x16x32_bf16 v[96:99], v[24:27], v[28:31], v[96:99]
    ds_read_b64_tr_b16 v[18:19], v4 offset:61952
    v_mfma_f32_16x16x32_bf16 v[100:103], v[24:27], v[32:35], v[100:103]
    ds_read_b128 v[68:71], v6 offset:35968
    v_mfma_f32_16x16x32_bf16 v[104:107], v[24:27], v[36:39], v[104:107]
    ds_read_b128 v[72:75], v6 offset:36096
    v_mfma_f32_16x16x32_bf16 v[108:111], v[24:27], v[40:43], v[108:111]
    v_mfma_f32_16x16x32_bf16 v[112:115], v[24:27], v[44:47], v[112:115]
    v_mfma_f32_16x16x32_bf16 v[116:119], v[24:27], v[48:51], v[116:119]
    v_mfma_f32_16x16x32_bf16 v[120:123], v[24:27], v[52:55], v[120:123]
    s_barrier
    s_waitcnt lgkmcnt(6)
    v_mfma_f32_16x16x32_bf16 v[92:95], v[12:15], v[28:31], v[92:95]
    ds_read_b64_tr_b16 v[20:21], v142 offset:0
    v_mfma_f32_16x16x32_bf16 v[96:99], v[12:15], v[32:35], v[96:99]
    ds_read_b64_tr_b16 v[22:23], v142 offset:512
    v_mfma_f32_16x16x32_bf16 v[100:103], v[12:15], v[36:39], v[100:103]
    ds_read_b128 v[76:79], v6 offset:36224
    v_mfma_f32_16x16x32_bf16 v[104:107], v[12:15], v[40:43], v[104:107]
    ds_read_b128 v[80:83], v6 offset:36352
    v_mfma_f32_16x16x32_bf16 v[108:111], v[12:15], v[44:47], v[108:111]
    v_mfma_f32_16x16x32_bf16 v[112:115], v[12:15], v[48:51], v[112:115]
    v_mfma_f32_16x16x32_bf16 v[116:119], v[12:15], v[52:55], v[116:119]
    v_mfma_f32_16x16x32_bf16 v[120:123], v[12:15], v[56:59], v[120:123]
    s_waitcnt lgkmcnt(6)
    v_mfma_f32_16x16x32_bf16 v[92:95], v[16:19], v[32:35], v[92:95]
    ds_read_b64_tr_b16 v[24:25], v142 offset:4096
    v_mfma_f32_16x16x32_bf16 v[96:99], v[16:19], v[36:39], v[96:99]
    ds_read_b64_tr_b16 v[26:27], v142 offset:4608
    v_mfma_f32_16x16x32_bf16 v[100:103], v[16:19], v[40:43], v[100:103]
    ds_read_b128 v[84:87], v6 offset:36480
    v_mfma_f32_16x16x32_bf16 v[104:107], v[16:19], v[44:47], v[104:107]
    ds_read_b128 v[88:91], v6 offset:36608
    v_mfma_f32_16x16x32_bf16 v[108:111], v[16:19], v[48:51], v[108:111]
    v_mfma_f32_16x16x32_bf16 v[112:115], v[16:19], v[52:55], v[112:115]
    v_mfma_f32_16x16x32_bf16 v[116:119], v[16:19], v[56:59], v[116:119]
    v_mfma_f32_16x16x32_bf16 v[120:123], v[16:19], v[60:63], v[120:123]
    s_waitcnt lgkmcnt(6)
    v_mfma_f32_16x16x32_bf16 v[92:95], v[20:23], v[36:39], v[92:95]
    ds_read_b64_tr_b16 v[12:13], v142 offset:8192
    v_mfma_f32_16x16x32_bf16 v[96:99], v[20:23], v[40:43], v[96:99]
    ds_read_b64_tr_b16 v[14:15], v142 offset:8704
    v_mfma_f32_16x16x32_bf16 v[100:103], v[20:23], v[44:47], v[100:103]
    ds_read_b128 v[28:31], v6 offset:36736
    v_mfma_f32_16x16x32_bf16 v[104:107], v[20:23], v[48:51], v[104:107]
    ds_read_b128 v[32:35], v6 offset:36864
    v_mfma_f32_16x16x32_bf16 v[108:111], v[20:23], v[52:55], v[108:111]
    v_mfma_f32_16x16x32_bf16 v[112:115], v[20:23], v[56:59], v[112:115]
    v_mfma_f32_16x16x32_bf16 v[116:119], v[20:23], v[60:63], v[116:119]
    buffer_load_dword v134, v134, s[64:67], 0 offen sc1
    v_mfma_f32_16x16x32_bf16 v[120:123], v[20:23], v[64:67], v[120:123]
    s_waitcnt lgkmcnt(0)
    v_mfma_f32_16x16x32_bf16 v[92:95], v[24:27], v[68:71], v[92:95]
    ds_read_b64_tr_b16 v[16:17], v142 offset:12288
    v_mfma_f32_16x16x32_bf16 v[96:99], v[24:27], v[72:75], v[96:99]
    ds_read_b64_tr_b16 v[18:19], v142 offset:12800
    v_mfma_f32_16x16x32_bf16 v[100:103], v[24:27], v[76:79], v[100:103]
    ds_read_b128 v[36:39], v6 offset:37024
    v_mfma_f32_16x16x32_bf16 v[104:107], v[24:27], v[80:83], v[104:107]
    ds_read_b128 v[40:43], v6 offset:37152
    v_mfma_f32_16x16x32_bf16 v[108:111], v[24:27], v[84:87], v[108:111]
    v_mfma_f32_16x16x32_bf16 v[112:115], v[24:27], v[88:91], v[112:115]
    v_mfma_f32_16x16x32_bf16 v[116:119], v[24:27], v[28:31], v[116:119]
    v_mfma_f32_16x16x32_bf16 v[120:123], v[24:27], v[32:35], v[120:123]
    s_barrier
    s_waitcnt lgkmcnt(1)
    v_mfma_f32_16x16x32_bf16 v[92:95], v[12:15], v[72:75], v[92:95]
    ds_read_b64_tr_b16 v[20:21], v142 offset:16384
    v_mfma_f32_16x16x32_bf16 v[96:99], v[12:15], v[76:79], v[96:99]
    ds_read_b64_tr_b16 v[22:23], v142 offset:16896
    v_mfma_f32_16x16x32_bf16 v[100:103], v[12:15], v[80:83], v[100:103]
    ds_read_b128 v[44:47], v6 offset:37280
    v_mfma_f32_16x16x32_bf16 v[104:107], v[12:15], v[84:87], v[104:107]
    ds_read_b128 v[48:51], v6 offset:37408
    v_mfma_f32_16x16x32_bf16 v[108:111], v[12:15], v[88:91], v[108:111]
    v_mfma_f32_16x16x32_bf16 v[112:115], v[12:15], v[28:31], v[112:115]
    v_mfma_f32_16x16x32_bf16 v[116:119], v[12:15], v[32:35], v[116:119]
    v_mfma_f32_16x16x32_bf16 v[120:123], v[12:15], v[36:39], v[120:123]
    s_waitcnt lgkmcnt(4)
    v_mfma_f32_16x16x32_bf16 v[92:95], v[16:19], v[76:79], v[92:95]
    ds_read_b64_tr_b16 v[24:25], v142 offset:20480
    v_mfma_f32_16x16x32_bf16 v[96:99], v[16:19], v[80:83], v[96:99]
    ds_read_b64_tr_b16 v[26:27], v142 offset:20992
    v_mfma_f32_16x16x32_bf16 v[100:103], v[16:19], v[84:87], v[100:103]
    ds_read_b128 v[52:55], v6 offset:37536
    v_mfma_f32_16x16x32_bf16 v[104:107], v[16:19], v[88:91], v[104:107]
    ds_read_b128 v[56:59], v6 offset:37664
    v_mfma_f32_16x16x32_bf16 v[108:111], v[16:19], v[28:31], v[108:111]
    v_mfma_f32_16x16x32_bf16 v[112:115], v[16:19], v[32:35], v[112:115]
    v_mfma_f32_16x16x32_bf16 v[116:119], v[16:19], v[36:39], v[116:119]
    v_mfma_f32_16x16x32_bf16 v[120:123], v[16:19], v[40:43], v[120:123]
    s_waitcnt lgkmcnt(5)
    v_mfma_f32_16x16x32_bf16 v[92:95], v[20:23], v[80:83], v[92:95]
    ds_read_b64_tr_b16 v[12:13], v4 offset:0
    v_mfma_f32_16x16x32_bf16 v[96:99], v[20:23], v[84:87], v[96:99]
    ds_read_b64_tr_b16 v[14:15], v4 offset:512
    v_mfma_f32_16x16x32_bf16 v[100:103], v[20:23], v[88:91], v[100:103]
    ds_read_b128 v[60:63], v6 offset:53856
    v_mfma_f32_16x16x32_bf16 v[104:107], v[20:23], v[28:31], v[104:107]
    ds_read_b128 v[64:67], v6 offset:53984
    v_mfma_f32_16x16x32_bf16 v[108:111], v[20:23], v[32:35], v[108:111]
    v_mfma_f32_16x16x32_bf16 v[112:115], v[20:23], v[36:39], v[112:115]
    v_mfma_f32_16x16x32_bf16 v[116:119], v[20:23], v[40:43], v[116:119]
    v_mfma_f32_16x16x32_bf16 v[120:123], v[20:23], v[44:47], v[120:123]
    s_waitcnt lgkmcnt(6)
    v_mfma_f32_16x16x32_bf16 v[92:95], v[24:27], v[84:87], v[92:95]
    ds_read_b64_tr_b16 v[16:17], v4 offset:4096
    v_mfma_f32_16x16x32_bf16 v[96:99], v[24:27], v[88:91], v[96:99]
    ds_read_b64_tr_b16 v[18:19], v4 offset:4608
    v_mfma_f32_16x16x32_bf16 v[100:103], v[24:27], v[28:31], v[100:103]
    ds_read_b128 v[68:71], v6 offset:54112
    v_mfma_f32_16x16x32_bf16 v[104:107], v[24:27], v[32:35], v[104:107]
    ds_read_b128 v[72:75], v6 offset:54240
    v_mfma_f32_16x16x32_bf16 v[108:111], v[24:27], v[36:39], v[108:111]
    v_mfma_f32_16x16x32_bf16 v[112:115], v[24:27], v[40:43], v[112:115]
    v_mfma_f32_16x16x32_bf16 v[116:119], v[24:27], v[44:47], v[116:119]
    v_mfma_f32_16x16x32_bf16 v[120:123], v[24:27], v[48:51], v[120:123]
    s_barrier
    s_waitcnt lgkmcnt(6)
    v_mfma_f32_16x16x32_bf16 v[92:95], v[12:15], v[88:91], v[92:95]
    ds_read_b64_tr_b16 v[20:21], v4 offset:8192
    v_mfma_f32_16x16x32_bf16 v[96:99], v[12:15], v[28:31], v[96:99]
    ds_read_b64_tr_b16 v[22:23], v4 offset:8704
    v_mfma_f32_16x16x32_bf16 v[100:103], v[12:15], v[32:35], v[100:103]
    ds_read_b128 v[76:79], v6 offset:54368
    v_mfma_f32_16x16x32_bf16 v[104:107], v[12:15], v[36:39], v[104:107]
    ds_read_b128 v[80:83], v6 offset:54496
    v_mfma_f32_16x16x32_bf16 v[108:111], v[12:15], v[40:43], v[108:111]
    v_mfma_f32_16x16x32_bf16 v[112:115], v[12:15], v[44:47], v[112:115]
    v_mfma_f32_16x16x32_bf16 v[116:119], v[12:15], v[48:51], v[116:119]
    v_mfma_f32_16x16x32_bf16 v[120:123], v[12:15], v[52:55], v[120:123]
    s_waitcnt lgkmcnt(6)
    v_mfma_f32_16x16x32_bf16 v[92:95], v[16:19], v[28:31], v[92:95]
    ds_read_b64_tr_b16 v[24:25], v4 offset:12288
    v_mfma_f32_16x16x32_bf16 v[96:99], v[16:19], v[32:35], v[96:99]
    ds_read_b64_tr_b16 v[26:27], v4 offset:12800
    v_mfma_f32_16x16x32_bf16 v[100:103], v[16:19], v[36:39], v[100:103]
    ds_read_b128 v[84:87], v6 offset:54624
    v_mfma_f32_16x16x32_bf16 v[104:107], v[16:19], v[40:43], v[104:107]
    ds_read_b128 v[88:91], v6 offset:54752
    v_mfma_f32_16x16x32_bf16 v[108:111], v[16:19], v[44:47], v[108:111]
    v_mfma_f32_16x16x32_bf16 v[112:115], v[16:19], v[48:51], v[112:115]
    v_mfma_f32_16x16x32_bf16 v[116:119], v[16:19], v[52:55], v[116:119]
    v_mfma_f32_16x16x32_bf16 v[120:123], v[16:19], v[56:59], v[120:123]
    s_waitcnt lgkmcnt(0)
    v_mfma_f32_16x16x32_bf16 v[92:95], v[20:23], v[60:63], v[92:95]
    ds_read_b64_tr_b16 v[12:13], v4 offset:16384
    v_mfma_f32_16x16x32_bf16 v[96:99], v[20:23], v[64:67], v[96:99]
    ds_read_b64_tr_b16 v[14:15], v4 offset:16896
    v_mfma_f32_16x16x32_bf16 v[100:103], v[20:23], v[68:71], v[100:103]
    ds_read_b128 v[28:31], v6 offset:54912
    v_mfma_f32_16x16x32_bf16 v[104:107], v[20:23], v[72:75], v[104:107]
    ds_read_b128 v[32:35], v6 offset:55040
    v_mfma_f32_16x16x32_bf16 v[108:111], v[20:23], v[76:79], v[108:111]
    v_mfma_f32_16x16x32_bf16 v[112:115], v[20:23], v[80:83], v[112:115]
    v_mfma_f32_16x16x32_bf16 v[116:119], v[20:23], v[84:87], v[116:119]
    v_mfma_f32_16x16x32_bf16 v[120:123], v[20:23], v[88:91], v[120:123]
    s_waitcnt lgkmcnt(1)
    v_mfma_f32_16x16x32_bf16 v[92:95], v[24:27], v[64:67], v[92:95]
    ds_read_b64_tr_b16 v[16:17], v4 offset:20480
    v_mfma_f32_16x16x32_bf16 v[96:99], v[24:27], v[68:71], v[96:99]
    ds_read_b64_tr_b16 v[18:19], v4 offset:20992
    v_mfma_f32_16x16x32_bf16 v[100:103], v[24:27], v[72:75], v[100:103]
    ds_read_b128 v[36:39], v6 offset:55168
    v_mfma_f32_16x16x32_bf16 v[104:107], v[24:27], v[76:79], v[104:107]
    ds_read_b128 v[40:43], v6 offset:55296
    v_mfma_f32_16x16x32_bf16 v[108:111], v[24:27], v[80:83], v[108:111]
    v_mfma_f32_16x16x32_bf16 v[112:115], v[24:27], v[84:87], v[112:115]
    v_mfma_f32_16x16x32_bf16 v[116:119], v[24:27], v[88:91], v[116:119]
    v_mfma_f32_16x16x32_bf16 v[120:123], v[24:27], v[28:31], v[120:123]
    s_barrier
    s_waitcnt lgkmcnt(4)
    v_mfma_f32_16x16x32_bf16 v[92:95], v[12:15], v[68:71], v[92:95]
    ds_read_b64_tr_b16 v[20:21], v4 offset:24576
    v_mfma_f32_16x16x32_bf16 v[96:99], v[12:15], v[72:75], v[96:99]
    ds_read_b64_tr_b16 v[22:23], v4 offset:25088
    v_mfma_f32_16x16x32_bf16 v[100:103], v[12:15], v[76:79], v[100:103]
    ds_read_b128 v[44:47], v6 offset:55424
    v_mfma_f32_16x16x32_bf16 v[104:107], v[12:15], v[80:83], v[104:107]
    ds_read_b128 v[48:51], v6 offset:55552
    v_mfma_f32_16x16x32_bf16 v[108:111], v[12:15], v[84:87], v[108:111]
    v_mfma_f32_16x16x32_bf16 v[112:115], v[12:15], v[88:91], v[112:115]
    v_mfma_f32_16x16x32_bf16 v[116:119], v[12:15], v[28:31], v[116:119]
    v_mfma_f32_16x16x32_bf16 v[120:123], v[12:15], v[32:35], v[120:123]
    s_waitcnt lgkmcnt(5)
    v_mfma_f32_16x16x32_bf16 v[92:95], v[16:19], v[72:75], v[92:95]
    ds_read_b64_tr_b16 v[24:25], v4 offset:28672
    v_mfma_f32_16x16x32_bf16 v[96:99], v[16:19], v[76:79], v[96:99]
    ds_read_b64_tr_b16 v[26:27], v4 offset:29184
    v_mfma_f32_16x16x32_bf16 v[100:103], v[16:19], v[80:83], v[100:103]
    ds_read_b128 v[52:55], v6 offset:53920
    v_mfma_f32_16x16x32_bf16 v[104:107], v[16:19], v[84:87], v[104:107]
    ds_read_b128 v[56:59], v6 offset:54048
    v_mfma_f32_16x16x32_bf16 v[108:111], v[16:19], v[88:91], v[108:111]
    v_mfma_f32_16x16x32_bf16 v[112:115], v[16:19], v[28:31], v[112:115]
    v_mfma_f32_16x16x32_bf16 v[116:119], v[16:19], v[32:35], v[116:119]
    v_mfma_f32_16x16x32_bf16 v[120:123], v[16:19], v[36:39], v[120:123]
    s_waitcnt lgkmcnt(6)
    v_mfma_f32_16x16x32_bf16 v[92:95], v[20:23], v[76:79], v[92:95]
    ds_read_b64_tr_b16 v[12:13], v4 offset:32768
    v_mfma_f32_16x16x32_bf16 v[96:99], v[20:23], v[80:83], v[96:99]
    ds_read_b64_tr_b16 v[14:15], v4 offset:33280
    v_mfma_f32_16x16x32_bf16 v[100:103], v[20:23], v[84:87], v[100:103]
    ds_read_b128 v[60:63], v6 offset:54176
    v_mfma_f32_16x16x32_bf16 v[104:107], v[20:23], v[88:91], v[104:107]
    ds_read_b128 v[64:67], v6 offset:54304
    v_mfma_f32_16x16x32_bf16 v[108:111], v[20:23], v[28:31], v[108:111]
    v_mfma_f32_16x16x32_bf16 v[112:115], v[20:23], v[32:35], v[112:115]
    v_mfma_f32_16x16x32_bf16 v[116:119], v[20:23], v[36:39], v[116:119]
    v_mfma_f32_16x16x32_bf16 v[120:123], v[20:23], v[40:43], v[120:123]
    s_waitcnt lgkmcnt(6)
    v_mfma_f32_16x16x32_bf16 v[92:95], v[24:27], v[80:83], v[92:95]
    ds_read_b64_tr_b16 v[16:17], v4 offset:36864
    v_mfma_f32_16x16x32_bf16 v[96:99], v[24:27], v[84:87], v[96:99]
    ds_read_b64_tr_b16 v[18:19], v4 offset:37376
    v_mfma_f32_16x16x32_bf16 v[100:103], v[24:27], v[88:91], v[100:103]
    ds_read_b128 v[68:71], v6 offset:54432
    v_mfma_f32_16x16x32_bf16 v[104:107], v[24:27], v[28:31], v[104:107]
    ds_read_b128 v[72:75], v6 offset:54560
    v_mfma_f32_16x16x32_bf16 v[108:111], v[24:27], v[32:35], v[108:111]
    v_mfma_f32_16x16x32_bf16 v[112:115], v[24:27], v[36:39], v[112:115]
    v_mfma_f32_16x16x32_bf16 v[116:119], v[24:27], v[40:43], v[116:119]
    v_mfma_f32_16x16x32_bf16 v[120:123], v[24:27], v[44:47], v[120:123]
    s_barrier
    s_waitcnt lgkmcnt(6)
    v_mfma_f32_16x16x32_bf16 v[92:95], v[12:15], v[84:87], v[92:95]
    ds_read_b64_tr_b16 v[20:21], v4 offset:40960
    v_mfma_f32_16x16x32_bf16 v[96:99], v[12:15], v[88:91], v[96:99]
    ds_read_b64_tr_b16 v[22:23], v4 offset:41472
    v_mfma_f32_16x16x32_bf16 v[100:103], v[12:15], v[28:31], v[100:103]
    ds_read_b128 v[76:79], v6 offset:54688
    v_mfma_f32_16x16x32_bf16 v[104:107], v[12:15], v[32:35], v[104:107]
    ds_read_b128 v[80:83], v6 offset:54816
    v_mfma_f32_16x16x32_bf16 v[108:111], v[12:15], v[36:39], v[108:111]
    v_mfma_f32_16x16x32_bf16 v[112:115], v[12:15], v[40:43], v[112:115]
    s_waitcnt vmcnt(0)
    v_mfma_f32_16x16x32_bf16 v[116:119], v[12:15], v[44:47], v[116:119]
    v_readfirstlane_b32 s47, v134
    v_mfma_f32_16x16x32_bf16 v[120:123], v[12:15], v[48:51], v[120:123]
    s_cmp_eq_u32 s47, s97
    s_cselect_b32 s97, 1, 0
    s_waitcnt lgkmcnt(0)
    v_mfma_f32_16x16x32_bf16 v[92:95], v[16:19], v[52:55], v[92:95]
    ds_read_b64_tr_b16 v[24:25], v4 offset:45056
    v_mfma_f32_16x16x32_bf16 v[96:99], v[16:19], v[56:59], v[96:99]
    ds_read_b64_tr_b16 v[26:27], v4 offset:45568
    v_mfma_f32_16x16x32_bf16 v[100:103], v[16:19], v[60:63], v[100:103]
    ds_read_b128 v[84:87], v6 offset:54976
    v_mfma_f32_16x16x32_bf16 v[104:107], v[16:19], v[64:67], v[104:107]
    ds_read_b128 v[88:91], v6 offset:55104
    v_mfma_f32_16x16x32_bf16 v[108:111], v[16:19], v[68:71], v[108:111]
    v_mfma_f32_16x16x32_bf16 v[112:115], v[16:19], v[72:75], v[112:115]
    v_mfma_f32_16x16x32_bf16 v[116:119], v[16:19], v[76:79], v[116:119]
    v_mfma_f32_16x16x32_bf16 v[120:123], v[16:19], v[80:83], v[120:123]
    s_waitcnt lgkmcnt(1)
    v_mfma_f32_16x16x32_bf16 v[92:95], v[20:23], v[56:59], v[92:95]
    ds_read_b64_tr_b16 v[12:13], v4 offset:49152
    v_mfma_f32_16x16x32_bf16 v[96:99], v[20:23], v[60:63], v[96:99]
    ds_read_b64_tr_b16 v[14:15], v4 offset:49664
    v_mfma_f32_16x16x32_bf16 v[100:103], v[20:23], v[64:67], v[100:103]
    ds_read_b128 v[28:31], v6 offset:55232
    v_mfma_f32_16x16x32_bf16 v[104:107], v[20:23], v[68:71], v[104:107]
    ds_read_b128 v[32:35], v6 offset:55360
    v_mfma_f32_16x16x32_bf16 v[108:111], v[20:23], v[72:75], v[108:111]
    v_mfma_f32_16x16x32_bf16 v[112:115], v[20:23], v[76:79], v[112:115]
    v_mfma_f32_16x16x32_bf16 v[116:119], v[20:23], v[80:83], v[116:119]
    v_mfma_f32_16x16x32_bf16 v[120:123], v[20:23], v[84:87], v[120:123]
    s_waitcnt lgkmcnt(4)
    v_mfma_f32_16x16x32_bf16 v[92:95], v[24:27], v[60:63], v[92:95]
    ds_read_b64_tr_b16 v[16:17], v4 offset:53248
    v_mfma_f32_16x16x32_bf16 v[96:99], v[24:27], v[64:67], v[96:99]
    ds_read_b64_tr_b16 v[18:19], v4 offset:53760
    v_mfma_f32_16x16x32_bf16 v[100:103], v[24:27], v[68:71], v[100:103]
    ds_read_b128 v[36:39], v6 offset:55488
    v_mfma_f32_16x16x32_bf16 v[104:107], v[24:27], v[72:75], v[104:107]
    ds_read_b128 v[40:43], v6 offset:55616
    v_mfma_f32_16x16x32_bf16 v[108:111], v[24:27], v[76:79], v[108:111]
    v_mfma_f32_16x16x32_bf16 v[112:115], v[24:27], v[80:83], v[112:115]
    v_mfma_f32_16x16x32_bf16 v[116:119], v[24:27], v[84:87], v[116:119]
    v_mfma_f32_16x16x32_bf16 v[120:123], v[24:27], v[88:91], v[120:123]
    s_barrier
    s_waitcnt lgkmcnt(5)
    v_mfma_f32_16x16x32_bf16 v[92:95], v[12:15], v[64:67], v[92:95]
    ds_read_b64_tr_b16 v[20:21], v4 offset:57344
    v_mfma_f32_16x16x32_bf16 v[96:99], v[12:15], v[68:71], v[96:99]
    ds_read_b64_tr_b16 v[22:23], v4 offset:57856
    v_mfma_f32_16x16x32_bf16 v[100:103], v[12:15], v[72:75], v[100:103]
    ds_read_b64_tr_b16 v[24:25], v4 offset:61440
    v_mfma_f32_16x16x32_bf16 v[104:107], v[12:15], v[76:79], v[104:107]
    ds_read_b64_tr_b16 v[26:27], v4 offset:61952
    v_mfma_f32_16x16x32_bf16 v[108:111], v[12:15], v[80:83], v[108:111]
    v_mfma_f32_16x16x32_bf16 v[112:115], v[12:15], v[84:87], v[112:115]
    v_mfma_f32_16x16x32_bf16 v[116:119], v[12:15], v[88:91], v[116:119]
    v_mfma_f32_16x16x32_bf16 v[120:123], v[12:15], v[28:31], v[120:123]
    s_waitcnt lgkmcnt(0)
    s_cmp_eq_u32 s97, 1
    s_cbranch_scc0 L_fin_slow
    v_mfma_f32_16x16x32_bf16 v[92:95], v[16:19], v[68:71], v[92:95]
    v_mfma_f32_16x16x32_bf16 v[92:95], v[20:23], v[72:75], v[92:95]
    v_mfma_f32_16x16x32_bf16 v[92:95], v[24:27], v[76:79], v[92:95]
    v_mfma_f32_16x16x32_bf16 v[96:99], v[16:19], v[72:75], v[96:99]
    v_mfma_f32_16x16x32_bf16 v[96:99], v[20:23], v[76:79], v[96:99]
    v_mfma_f32_16x16x32_bf16 v[96:99], v[24:27], v[80:83], v[96:99]
    v_mfma_f32_16x16x32_bf16 v[100:103], v[16:19], v[76:79], v[100:103]
    v_mfma_f32_16x16x32_bf16 v[100:103], v[20:23], v[80:83], v[100:103]
    v_mfma_f32_16x16x32_bf16 v[100:103], v[24:27], v[84:87], v[100:103]
    v_mfma_f32_16x16x32_bf16 v[104:107], v[16:19], v[80:83], v[104:107]
    v_mfma_f32_16x16x32_bf16 v[104:107], v[20:23], v[84:87], v[104:107]
    v_mfma_f32_16x16x32_bf16 v[104:107], v[24:27], v[88:91], v[104:107]
    v_mfma_f32_16x16x32_bf16 v[108:111], v[16:19], v[84:87], v[108:111]
    v_mfma_f32_16x16x32_bf16 v[108:111], v[20:23], v[88:91], v[108:111]
    v_cvt_pk_bf16_f32 v92, v92, v93
    v_cvt_pk_bf16_f32 v93, v94, v95
    v_mfma_f32_16x16x32_bf16 v[108:111], v[24:27], v[28:31], v[108:111]
    v_cvt_pk_bf16_f32 v94, v96, v97
    v_cvt_pk_bf16_f32 v95, v98, v99
    v_mfma_f32_16x16x32_bf16 v[112:115], v[16:19], v[88:91], v[112:115]
    buffer_store_dwordx4 v[92:95], v7, s[28:31], 0 offen offset:0
    v_cvt_pk_bf16_f32 v100, v100, v101
    v_mfma_f32_16x16x32_bf16 v[112:115], v[20:23], v[28:31], v[112:115]
    v_cvt_pk_bf16_f32 v101, v102, v103
    v_cvt_pk_bf16_f32 v102, v104, v105
    v_mfma_f32_16x16x32_bf16 v[112:115], v[24:27], v[32:35], v[112:115]
    v_cvt_pk_bf16_f32 v103, v106, v107
    buffer_store_dwordx4 v[100:103], v7, s[28:31], 0 offen offset:256
    v_mfma_f32_16x16x32_bf16 v[116:119], v[16:19], v[28:31], v[116:119]
    v_mfma_f32_16x16x32_bf16 v[116:119], v[20:23], v[32:35], v[116:119]
    v_mfma_f32_16x16x32_bf16 v[116:119], v[24:27], v[36:39], v[116:119]
    v_mfma_f32_16x16x32_bf16 v[120:123], v[16:19], v[32:35], v[120:123]
    v_mfma_f32_16x16x32_bf16 v[120:123], v[20:23], v[36:39], v[120:123]
    v_mfma_f32_16x16x32_bf16 v[120:123], v[24:27], v[40:43], v[120:123]
    v_cvt_pk_bf16_f32 v108, v108, v109
    v_cvt_pk_bf16_f32 v109, v110, v111
    v_cvt_pk_bf16_f32 v110, v112, v113
    v_cvt_pk_bf16_f32 v111, v114, v115
    buffer_store_dwordx4 v[108:111], v7, s[28:31], 0 offen offset:512
    s_nop 2
    v_cvt_pk_bf16_f32 v116, v116, v117
    v_cvt_pk_bf16_f32 v117, v118, v119
    v_cvt_pk_bf16_f32 v118, v120, v121
    v_cvt_pk_bf16_f32 v119, v122, v123
    buffer_store_dwordx4 v[116:119], v7, s[28:31], 0 offen offset:768
    s_waitcnt vmcnt(0)
    s_mov_b64 exec, 15
    buffer_store_dword v124, v137, s[28:31], 0 offen
    s_mov_b64 exec, -1
    s_branch L_fin_done
L_fin_slow:
    v_mfma_f32_16x16x32_bf16 v[92:95], v[16:19], v[68:71], v[92:95]
    v_mfma_f32_16x16x32_bf16 v[92:95], v[20:23], v[72:75], v[92:95]
    v_mfma_f32_16x16x32_bf16 v[92:95], v[24:27], v[76:79], v[92:95]
    v_mfma_f32_16x16x32_bf16 v[96:99], v[16:19], v[72:75], v[96:99]
    v_mfma_f32_16x16x32_bf16 v[96:99], v[20:23], v[76:79], v[96:99]
    v_mfma_f32_16x16x32_bf16 v[96:99], v[24:27], v[80:83], v[96:99]
    v_mfma_f32_16x16x32_bf16 v[100:103], v[16:19], v[76:79], v[100:103]
    v_mfma_f32_16x16x32_bf16 v[100:103], v[20:23], v[80:83], v[100:103]
    v_mfma_f32_16x16x32_bf16 v[100:103], v[24:27], v[84:87], v[100:103]
    v_mfma_f32_16x16x32_bf16 v[104:107], v[16:19], v[80:83], v[104:107]
    v_mfma_f32_16x16x32_bf16 v[104:107], v[20:23], v[84:87], v[104:107]
    v_mfma_f32_16x16x32_bf16 v[104:107], v[24:27], v[88:91], v[104:107]
    v_mfma_f32_16x16x32_bf16 v[108:111], v[16:19], v[84:87], v[108:111]
    v_mfma_f32_16x16x32_bf16 v[108:111], v[20:23], v[88:91], v[108:111]
    v_cvt_pk_bf16_f32 v92, v92, v93
    v_cvt_pk_bf16_f32 v93, v94, v95
    v_mfma_f32_16x16x32_bf16 v[108:111], v[24:27], v[28:31], v[108:111]
    v_cvt_pk_bf16_f32 v94, v96, v97
    v_cvt_pk_bf16_f32 v95, v98, v99
    v_mfma_f32_16x16x32_bf16 v[112:115], v[16:19], v[88:91], v[112:115]
    buffer_store_dwordx4 v[92:95], v7, s[28:31], 0 offen offset:0 sc1
    v_cvt_pk_bf16_f32 v100, v100, v101
    v_mfma_f32_16x16x32_bf16 v[112:115], v[20:23], v[28:31], v[112:115]
    v_cvt_pk_bf16_f32 v101, v102, v103
    v_cvt_pk_bf16_f32 v102, v104, v105
    v_mfma_f32_16x16x32_bf16 v[112:115], v[24:27], v[32:35], v[112:115]
    v_cvt_pk_bf16_f32 v103, v106, v107
    buffer_store_dwordx4 v[100:103], v7, s[28:31], 0 offen offset:256 sc1
    v_mfma_f32_16x16x32_bf16 v[116:119], v[16:19], v[28:31], v[116:119]
    v_mfma_f32_16x16x32_bf16 v[116:119], v[20:23], v[32:35], v[116:119]
    v_mfma_f32_16x16x32_bf16 v[116:119], v[24:27], v[36:39], v[116:119]
    v_mfma_f32_16x16x32_bf16 v[120:123], v[16:19], v[32:35], v[120:123]
    v_mfma_f32_16x16x32_bf16 v[120:123], v[20:23], v[36:39], v[120:123]
    v_mfma_f32_16x16x32_bf16 v[120:123], v[24:27], v[40:43], v[120:123]
    v_cvt_pk_bf16_f32 v108, v108, v109
    v_cvt_pk_bf16_f32 v109, v110, v111
    v_cvt_pk_bf16_f32 v110, v112, v113
    v_cvt_pk_bf16_f32 v111, v114, v115
    buffer_store_dwordx4 v[108:111], v7, s[28:31], 0 offen offset:512 sc1
    s_nop 2
    v_cvt_pk_bf16_f32 v116, v116, v117
    v_cvt_pk_bf16_f32 v117, v118, v119
    v_cvt_pk_bf16_f32 v118, v120, v121
    v_cvt_pk_bf16_f32 v119, v122, v123
    buffer_store_dwordx4 v[116:119], v7, s[28:31], 0 offen offset:768 sc1
    s_waitcnt vmcnt(0)
    s_mov_b64 exec, 15
    buffer_store_dword v124, v137, s[28:31], 0 offen sc1
    s_mov_b64 exec, -1
L_fin_done:
L_epi:
L_poll:
    buffer_load_dwordx4 v[12:15], v136, s[28:31], 0 offen sc1
    s_waitcnt vmcnt(0)
    v_xor_b32 v12, v12, v124
    v_xor_b32 v13, v13, v124
    v_xor_b32 v14, v14, v124
    v_xor_b32 v15, v15, v124
    v_or3_b32 v12, v12, v13, v14
    v_or_b32 v12, v12, v15
    v_cmp_ne_u32 vcc, 0, v12
    s_cbranch_vccz L_got
    s_sub_u32 s100, s100, 1
    s_cmp_lg_u32 s100, 0
    s_cbranch_scc1 L_poll
L_got:
    buffer_load_dwordx4 v[16:19], v8, s[28:31], 0 offen sc1
    buffer_load_dwordx4 v[20:23], v8, s[28:31], 0 offen offset:2048 sc1
    s_waitcnt vmcnt(0)
    v_lshlrev_b32 v24, 16, v16
    v_and_b32 v25, 0xffff0000, v16
    v_lshlrev_b32 v26, 16, v17
    v_and_b32 v27, 0xffff0000, v17
    v_lshlrev_b32 v28, 16, v18
    v_and_b32 v29, 0xffff0000, v18
    v_lshlrev_b32 v30, 16, v19
    v_and_b32 v31, 0xffff0000, v19
    v_lshlrev_b32 v32, 16, v20
    v_and_b32 v33, 0xffff0000, v20
    v_lshlrev_b32 v34, 16, v21
    v_and_b32 v35, 0xffff0000, v21
    v_lshlrev_b32 v36, 16, v22
    v_and_b32 v37, 0xffff0000, v22
    v_lshlrev_b32 v38, 16, v23
    v_and_b32 v39, 0xffff0000, v23
    v_pk_add_f32 v[12:13], v[24:25], v[32:33]
    v_pk_add_f32 v[14:15], v[26:27], v[34:35]
    v_pk_add_f32 v[16:17], v[28:29], v[36:37]
    v_pk_add_f32 v[18:19], v[30:31], v[38:39]
    s_nop 0
    v_permlane32_swap_b32 v12, v16
    v_permlane32_swap_b32 v13, v17
    v_permlane32_swap_b32 v14, v18
    v_permlane32_swap_b32 v15, v19
    v_pk_add_f32 v[12:13], v[12:13], v[16:17]
    v_pk_add_f32 v[14:15], v[14:15], v[18:19]
    v_pk_add_f32 v[12:13], v[12:13], s[90:91]
    v_pk_add_f32 v[14:15], v[14:15], s[92:93]
    s_nop 0
    v_readfirstlane_b32 s48, v12
    v_readfirstlane_b32 s49, v13
    v_readfirstlane_b32 s50, v14
    v_readfirstlane_b32 s51, v15
    s_mov_b32 exec_hi, -1
    v_pk_add_f32 v[16:17], v[12:13], s[48:49] neg_lo:[0,1] neg_hi:[0,1]
    v_pk_add_f32 v[18:19], v[14:15], s[50:51] neg_lo:[0,1] neg_hi:[0,1]
    v_mov_b32 v24, s48
    v_cndmask_b32 v16, 0, v16, s[62:63]
    v_cndmask_b32 v17, 0, v17, s[62:63]
    v_cndmask_b32 v18, 0, v18, s[62:63]
    v_cndmask_b32 v19, 0, v19, s[62:63]
    v_pk_mul_f32 v[20:21], v[16:17], v[16:17]
    v_pk_mul_f32 v[22:23], v[18:19], v[18:19]
    v_writelane_b32 v24, s50, 16
    v_permlane32_swap_b32 v16, v17
    v_permlane32_swap_b32 v18, v19
    v_permlane32_swap_b32 v20, v21
    v_permlane32_swap_b32 v22, v23
    v_add_f32 v16, v16, v17
    v_add_f32 v18, v18, v19
    v_add_f32 v20, v20, v21
    v_add_f32 v22, v22, v23
    v_writelane_b32 v24, s49, 32
    v_permlane16_swap_b32 v16, v18
    v_permlane16_swap_b32 v20, v22
    v_writelane_b32 v24, s51, 48
    v_add_f32 v16, v16, v18
    v_add_f32 v20, v20, v22
    s_nop 0
    v_add_f32_dpp v16, v16, v16 row_ror:1 row_mask:0xf bank_mask:0xf
    v_add_f32_dpp v20, v20, v20 row_ror:1 row_mask:0xf bank_mask:0xf
    s_nop 0
    v_add_f32_dpp v16, v16, v16 row_ror:2 row_mask:0xf bank_mask:0xf
    v_add_f32_dpp v20, v20, v20 row_ror:2 row_mask:0xf bank_mask:0xf
    s_nop 0
    v_add_f32_dpp v16, v16, v16 row_ror:4 row_mask:0xf bank_mask:0xf
    v_add_f32_dpp v20, v20, v20 row_ror:4 row_mask:0xf bank_mask:0xf
    s_nop 0
    v_add_f32_dpp v16, v16, v16 row_ror:8 row_mask:0xf bank_mask:0xf
    v_add_f32_dpp v20, v20, v20 row_ror:8 row_mask:0xf bank_mask:0xf
    s_mov_b32 exec_lo, 0x00010001
    s_mov_b32 exec_hi, 0x00010001
    ds_write_b32 v130, v16
    ds_write_b32 v130, v20 offset:16
    ds_write_b32 v130, v24 offset:32
    s_mov_b64 exec, -1
    s_waitcnt lgkmcnt(0)
    s_barrier
    ds_read_b32 v16, v131
    ds_read_b32 v17, v131 offset:16
    ds_read_b32 v18, v131 offset:32
    ds_read_b32 v19, v128
    s_waitcnt lgkmcnt(0)
    v_sub_f32 v18, v18, v19
    v_fma_f32 v20, v18, v127, v16
    v_add_f32 v16, v16, v20
    v_fma_f32 v17, v18, v16, v17
    s_nop 0
    v_add_f32_dpp v20, v20, v20 row_ror:4 row_mask:0xf bank_mask:0xf
    s_nop 0
    v_add_f32_dpp v17, v17, v17 row_ror:4 row_mask:0xf bank_mask:0xf
    v_add_f32_dpp v20, v20, v20 row_ror:8 row_mask:0xf bank_mask:0xf
    s_nop 0
    v_add_f32_dpp v17, v17, v17 row_ror:8 row_mask:0xf bank_mask:0xf
    v_mov_b32 v21, v20
    s_nop 0
    v_mov_b32 v22, v17
    v_permlane16_swap_b32 v21, v20
    s_nop 0
    v_permlane16_swap_b32 v22, v17
    v_add_f32 v20, v20, v21
    v_add_f32 v17, v17, v22
    v_mul_f32 v20, s3, v20
    v_fma_f32 v17, v17, s3, v140
    v_fma_f32 v17, -v20, v20, v17
    v_add_f32 v20, v20, v19
    v_rsq_f32 v17, v17
    s_nop 0
    v_mul_f32 v17, v17, v125
    v_fma_f32 v20, -v20, v17, v126
    s_nop 1
    v_mov_b32_dpp v24, v20 quad_perm:[0,0,0,0] row_mask:0xf bank_mask:0xf
    v_mov_b32_dpp v25, v20 quad_perm:[1,1,1,1] row_mask:0xf bank_mask:0xf
    v_mov_b32_dpp v26, v20 quad_perm:[2,2,2,2] row_mask:0xf bank_mask:0xf
    v_mov_b32_dpp v27, v20 quad_perm:[3,3,3,3] row_mask:0xf bank_mask:0xf
    v_fmac_f32_dpp v24, v17, v12 quad_perm:[0,0,0,0] row_mask:0xf bank_mask:0xf
    v_fmac_f32_dpp v25, v17, v13 quad_perm:[1,1,1,1] row_mask:0xf bank_mask:0xf
    v_fmac_f32_dpp v26, v17, v14 quad_perm:[2,2,2,2] row_mask:0xf bank_mask:0xf
    v_fmac_f32_dpp v27, v17, v15 quad_perm:[3,3,3,3] row_mask:0xf bank_mask:0xf
    v_pk_mul_f32 v[12:13], v[24:25], v[24:25]
    v_pk_mul_f32 v[14:15], v[26:27], v[26:27]
    v_pk_fma_f32 v[12:13], v[12:13], s[98:99], v[138:139]
    v_pk_fma_f32 v[14:15], v[14:15], s[98:99], v[138:139]
    v_pk_mul_f32 v[12:13], v[12:13], v[24:25]
    v_pk_mul_f32 v[14:15], v[14:15], v[26:27]
    v_exp_f32 v12, v12
    v_exp_f32 v13, v13
    v_exp_f32 v14, v14
    v_exp_f32 v15, v15
    s_nop 0
    v_pk_add_f32 v[12:13], v[12:13], 1.0 op_sel_hi:[1,0]
    v_pk_add_f32 v[14:15], v[14:15], 1.0 op_sel_hi:[1,0]
    v_rcp_f32 v12, v12
    v_rcp_f32 v13, v13
    v_rcp_f32 v14, v14
    v_rcp_f32 v15, v15
    s_nop 0
    v_pk_mul_f32 v[24:25], v[24:25], v[12:13]
    v_pk_mul_f32 v[26:27], v[26:27], v[14:15]
    v_cvt_pk_bf16_f32 v24, v24, v25
    v_cvt_pk_bf16_f32 v25, v26, v27
    s_mov_b64 exec, s[62:63]
    buffer_store_dwordx2 v[24:25], v129, s[32:35], 0 offen
    s_or_b32 s47, s59, s36
    s_cmp_lg_u32 s47, 0
    s_cbranch_scc1 L_noepoch
    v_mov_b32 v28, s45
    s_lshl_b32 s47, s58, 7
    s_add_u32 s47, s47, 4194304
    v_mov_b32 v29, s47
    s_mov_b64 exec, 1
    buffer_store_dword v28, v29, s[28:31], 0 offen sc1
L_noepoch:
L_end:
    s_endpgm
.section .rodata,"a"
.p2align 6
.amdhsa_kernel standalone__self_sup_conv_stem_hubert__speech_kernel
  .amdhsa_next_free_vgpr 144
  .amdhsa_next_free_sgpr 102
  .amdhsa_accum_offset 144
  .amdhsa_group_segment_fixed_size 0
  .amdhsa_float_denorm_mode_32 3
  .amdhsa_kernarg_size 64
  .amdhsa_user_sgpr_count 2
  .amdhsa_user_sgpr_kernarg_segment_ptr 1
  .amdhsa_system_sgpr_workgroup_id_x 1
.end_amdhsa_kernel
```
